```python
import torch

def _softmax(x, axis=-1):
    return torch.softmax(x, dim=axis)
def _gelu(x):
    return torch.nn.functional.gelu(x, approximate="tanh")
def _silu(x):
    return torch.nn.functional.silu(x)
def _sigmoid(x):
    return torch.sigmoid(x)
def _layernorm(x, axis=-1, eps=1e-5):
    m = x.mean(dim=axis, keepdim=True)
    v = x.var(dim=axis, keepdim=True, unbiased=False)
    return (x - m) / torch.sqrt(v + eps)
def _scatter_add(tgt, idx, src, axis=0):
    return tgt.clone().index_add_(axis, idx, src)
def _segment_sum(src, seg, n):
    out = torch.zeros((n,) + src.shape[1:], dtype=src.dtype)
    return out.index_add_(0, seg, src)
def _pad(x, pw):
    flat = tuple(v for pair in reversed(pw) for v in pair)
    return torch.nn.functional.pad(x, flat)

kernel_name = 'sequential_preLN__mha_block_cached__swiglu_ffn__decode'

def setup_inputs():

    _w = (lambda a: (lambda t: t.to(torch.bfloat16) if t.is_floating_point() else t)(torch.as_tensor(a)))
    def _A_setup():
        B, Sq, D = 2, 1, 512
        H, Sk, Dh = 32, 16384, 128
        return {
            "x": _w((lambda *s: torch.randn(*s, dtype=torch.bfloat16) * 0.05)(B, Sq, D)),
            "k_cache": _w((lambda *s: torch.randn(*s, dtype=torch.bfloat16) * 3.2)(B, H, Sk, Dh)),
            "v_cache": _w((lambda *s: torch.randn(*s, dtype=torch.bfloat16) * 0.4)(B, H, Sk, Dh)),
            "wq": _w((lambda *s: torch.randn(*s, dtype=torch.bfloat16) * 3.2)(D, H * Dh) * (D ** -0.5)),
            "wo": _w((lambda *s: torch.randn(*s, dtype=torch.bfloat16) * 0.4)(H * Dh, D) * ((H * Dh) ** -0.5)),
        }
    _A_in = _A_setup()

    def _B_setup():
        B, S, D, F = 2, 1, 512, 1792
        return {
            "x": _w((lambda *s: torch.randn(*s, dtype=torch.bfloat16) * 0.05)(B, S, D)),
            "w_gate": _w((lambda *s: torch.randn(*s, dtype=torch.bfloat16) * 0.05)(D, F)),
            "w_up": _w((lambda *s: torch.randn(*s, dtype=torch.bfloat16) * 0.05)(D, F)),
            "w_down": _w((lambda *s: torch.randn(*s, dtype=torch.bfloat16) * 0.05)(F, D)),
        }
    _B_in = _B_setup()

    return {
        "A_x": _A_in["x"],
        "A_k_cache": _A_in["k_cache"],
        "A_v_cache": _A_in["v_cache"],
        "A_wq": _A_in["wq"],
        "A_wo": _A_in["wo"],
        "B_x": _B_in["x"],
        "B_w_gate": _B_in["w_gate"],
        "B_w_up": _B_in["w_up"],
        "B_w_down": _B_in["w_down"],
    }

def reference(A_x, A_k_cache, A_v_cache, A_wq, A_wo, B_x, B_w_gate, B_w_up, B_w_down):
    def _A_ref(x, k_cache, v_cache, wq, wo):
        B, Sq, D = x.shape
        H, Dh = 32, 128
        q = (lambda x, *d: x.permute(*d))((x @ wq).reshape(B, Sq, H, Dh), 0, 2, 1, 3)
        scores = torch.einsum("bhqd,bhkd->bhqk", q, k_cache) * (Dh ** -0.5)
        p = _softmax(scores, axis=-1)
        o = torch.einsum("bhqk,bhkd->bhqd", p, v_cache)
        return (lambda x, *d: x.permute(*d))(o, 0, 2, 1, 3).reshape(B, Sq, H * Dh) @ wo

    def _B_ref(x, w_gate, w_up, w_down):
        g = _silu(x @ w_gate)
        u = x @ w_up
        return (g * u) @ w_down

    x = A_x
    h = x + _A_ref(_layernorm(x, axis=-1), A_k_cache, A_v_cache, A_wq, A_wo)
    h2 = h + _B_ref(_layernorm(h, axis=-1), B_w_gate, B_w_up, B_w_down)
    return h2
```

```asm
; @launch grid=(256,1,1) block=(1024,1,1) lds=65472
.amdgcn_target "amdgcn-amd-amdhsa--gfx950"
.text
.globl sequential_preLN__mha_block_cached__swiglu_ffn__decode_kernel
.p2align 8
.type sequential_preLN__mha_block_cached__swiglu_ffn__decode_kernel,@function
sequential_preLN__mha_block_cached__swiglu_ffn__decode_kernel:
    s_cmp_ge_u32 s2, 256
    s_cbranch_scc1 L_DONE
    s_load_dwordx16 s[64:79], s[0:1], 0
    s_load_dwordx8 s[80:87], s[0:1], 64
    v_and_b32 v1, 63, v0
    v_lshrrev_b32 v2, 6, v0
    s_nop 0
    v_readfirstlane_b32 s14, v2
    s_and_b32 s10, s2, 7
    s_lshr_b32 s11, s2, 3
    s_and_b32 s17, s11, 3
    s_lshl_b32 s17, s17, 3
    s_add_u32 s17, s17, s10
    s_lshr_b32 s16, s11, 2
    s_and_b32 s16, s16, 1
    s_lshl_b32 s15, s16, 5
    s_add_u32 s15, s15, s17
    s_lshr_b32 s3, s11, 3
    s_lshl_b32 s18, s15, 2
    s_add_u32 s3, s3, s18
    s_and_b32 s90, s11, 1
    s_lshl_b32 s91, s10, 1
    s_add_u32 s90, s90, s91
    s_lshr_b32 s91, s11, 1
    s_mul_i32 s12, s10, 28
    s_add_u32 s12, s12, s11
    s_lshl_b32 s13, s10, 3
    s_add_u32 s13, s13, s11
    s_waitcnt lgkmcnt(0)
    s_lshl_b32 s18, s3, 20
    s_lshr_b32 s19, s3, 12
    s_add_u32 s88, s66, s18
    s_addc_u32 s89, s67, s19
    s_mov_b32 s20, s88
    s_and_b32 s21, s89, 0xffff
    s_mov_b32 s22, 1048576
    s_mov_b32 s23, 0x00020000
    s_add_u32 s88, s68, s18
    s_addc_u32 s89, s69, s19
    s_mov_b32 s24, s88
    s_and_b32 s25, s89, 0xffff
    s_mov_b32 s26, 1048576
    s_mov_b32 s27, 0x00020000
    s_lshl_b32 s18, s16, 10
    s_add_u32 s88, s64, s18
    s_addc_u32 s89, s65, 0
    s_mov_b32 s28, s88
    s_and_b32 s29, s89, 0xffff
    s_mov_b32 s30, 1024
    s_mov_b32 s31, 0x00020000
    s_lshl_b32 s18, s17, 8
    s_add_u32 s88, s70, s18
    s_addc_u32 s89, s71, 0
    s_sub_u32 s19, 0x400000, s18
    s_mov_b32 s32, s88
    s_and_b32 s33, s89, 0xffff
    s_mov_b32 s34, s19
    s_mov_b32 s35, 0x00020000
    s_mov_b32 s36, s86
    s_and_b32 s37, s87, 0xffff
    s_mov_b32 s38, 1048576
    s_mov_b32 s39, 0x00020000
    s_mov_b32 s40, s84
    s_and_b32 s41, s85, 0xffff
    s_mov_b32 s42, 256
    s_mov_b32 s43, 0x00020000
    s_lshl_b32 s18, s91, 18
    s_lshl_b32 s19, s90, 6
    s_add_u32 s18, s18, s19
    s_add_u32 s88, s72, s18
    s_addc_u32 s89, s73, 0
    s_sub_u32 s19, 0x400000, s18
    s_mov_b32 s44, s88
    s_and_b32 s45, s89, 0xffff
    s_mov_b32 s46, s19
    s_mov_b32 s47, 0x00020000
    s_lshl_b32 s18, s12, 4
    s_sub_u32 s19, 1835008, s18
    s_cmp_lt_u32 s11, 28
    s_cselect_b32 s19, s19, 0
    s_cselect_b32 s18, s18, 0
    s_add_u32 s88, s76, s18
    s_addc_u32 s89, s77, 0
    s_mov_b32 s48, s88
    s_and_b32 s49, s89, 0xffff
    s_mov_b32 s50, s19
    s_mov_b32 s51, 0x00020000
    s_add_u32 s88, s78, s18
    s_addc_u32 s89, s79, 0
    s_mov_b32 s52, s88
    s_and_b32 s53, s89, 0xffff
    s_mov_b32 s54, s19
    s_mov_b32 s55, 0x00020000
    s_lshl_b32 s18, s13, 4
    s_sub_u32 s19, 1835008, s18
    s_cmp_lt_u32 s11, 8
    s_cselect_b32 s19, s19, 0
    s_cselect_b32 s18, s18, 0
    s_add_u32 s88, s80, s18
    s_addc_u32 s89, s81, 0
    s_mov_b32 s56, s88
    s_and_b32 s57, s89, 0xffff
    s_mov_b32 s58, s19
    s_mov_b32 s59, 0x00020000
    s_mov_b32 s60, s82
    s_and_b32 s61, s83, 0xffff
    s_mov_b32 s62, 2048
    s_mov_b32 s63, 0x00020000
    s_cmp_ge_u32 s14, 2
    s_cbranch_scc1 L_CLEAN_SKIP
    v_mov_b32 v32, -1
    v_mov_b32 v33, -1
    v_lshlrev_b32 v3, 2, v0
    s_lshl_b32 s93, s3, 9
    buffer_store_dword v32, v3, s[36:39], s93 offen offset:0 sc1
    s_cmp_lg_u32 s14, 0
    s_cbranch_scc1 L_CLEAN_SKIP
    v_lshrrev_b32 v3, 5, v0
    v_and_b32 v34, 31, v0
    v_lshlrev_b32 v3, 11, v3
    v_lshl_add_u32 v3, v34, 2, v3
    s_lshl_b32 s93, s91, 12
    s_lshl_b32 s92, s90, 7
    s_add_u32 s93, s93, s92
    s_add_u32 s93, s93, 524288
    buffer_store_dword v32, v3, s[36:39], s93 offen sc1
    s_mov_b64 exec, 0xffff
    v_lshrrev_b32 v3, 3, v0
    v_and_b32 v34, 7, v0
    v_lshlrev_b32 v3, 13, v3
    v_lshl_add_u32 v3, v34, 2, v3
    s_lshl_b32 s93, s12, 5
    s_add_u32 s93, s93, 786432
    s_cmp_ge_u32 s11, 28
    s_cbranch_scc1 L_CLEAN_NOGU
    buffer_store_dword v32, v3, s[36:39], s93 offen sc1
L_CLEAN_NOGU:
    s_mov_b64 exec, 1
    v_mov_b32 v3, 0
    s_lshl_b32 s93, s3, 3
    s_add_u32 s93, s93, 262144
    buffer_store_dwordx2 v[32:33], v3, s[36:39], s93 offen sc1
    s_mov_b64 exec, -1
    s_nop 1
L_CLEAN_SKIP:
    v_lshlrev_b32 v3, 4, v1
    buffer_load_dwordx4 v[4:7], v3, s[28:31], 0 offen
    v_lshrrev_b32 v3, 4, v0
    v_lshlrev_b32 v3, 13, v3
    v_and_b32 v24, 15, v0
    v_lshl_add_u32 v3, v24, 4, v3
    s_mov_b32 s93, 0
    buffer_load_dwordx4 v[48:51], v3, s[32:35], s93 offen
    s_mov_b32 s93, 524288
    buffer_load_dwordx4 v[52:55], v3, s[32:35], s93 offen
    s_mov_b32 s93, 1048576
    buffer_load_dwordx4 v[56:59], v3, s[32:35], s93 offen
    s_mov_b32 s93, 1572864
    buffer_load_dwordx4 v[60:63], v3, s[32:35], s93 offen
    s_mov_b32 s93, 2097152
    buffer_load_dwordx4 v[28:31], v3, s[32:35], s93 offen
    s_mov_b32 s93, 2621440
    buffer_load_dwordx4 v[32:35], v3, s[32:35], s93 offen
    s_mov_b32 s93, 3145728
    buffer_load_dwordx4 v[36:39], v3, s[32:35], s93 offen
    s_mov_b32 s93, 3670016
    buffer_load_dwordx4 v[40:43], v3, s[32:35], s93 offen
    v_lshlrev_b32 v46, 13, v2
    v_lshl_add_u32 v46, v1, 4, v46
    v_add_u32 v47, 4096, v46
    s_mov_b32 s94, 0
    buffer_load_dwordx4 v[64:67], v46, s[20:23], s94 offen offset:0 nt
    buffer_load_dwordx4 v[68:71], v46, s[20:23], s94 offen offset:1024 nt
    buffer_load_dwordx4 v[72:75], v46, s[20:23], s94 offen offset:2048 nt
    buffer_load_dwordx4 v[76:79], v46, s[20:23], s94 offen offset:3072 nt
    buffer_load_dwordx4 v[80:83], v47, s[20:23], s94 offen offset:0 nt
    buffer_load_dwordx4 v[84:87], v47, s[20:23], s94 offen offset:1024 nt
    buffer_load_dwordx4 v[88:91], v47, s[20:23], s94 offen offset:2048 nt
    buffer_load_dwordx4 v[92:95], v47, s[20:23], s94 offen offset:3072 nt
    buffer_load_dwordx4 v[96:99], v46, s[24:27], s94 offen offset:0 nt
    buffer_load_dwordx4 v[100:103], v46, s[24:27], s94 offen offset:1024 nt
    buffer_load_dwordx4 v[104:107], v46, s[24:27], s94 offen offset:2048 nt
    buffer_load_dwordx4 v[108:111], v46, s[24:27], s94 offen offset:3072 nt
    buffer_load_dwordx4 v[112:115], v47, s[24:27], s94 offen offset:0 nt
    buffer_load_dwordx4 v[116:119], v47, s[24:27], s94 offen offset:1024 nt
    buffer_load_dwordx4 v[120:123], v47, s[24:27], s94 offen offset:2048 nt
    buffer_load_dwordx4 v[124:127], v47, s[24:27], s94 offen offset:3072 nt
    s_waitcnt vmcnt(24)
    v_lshlrev_b32 v8, 16, v4
    v_and_b32 v9, 0xffff0000, v4
    v_lshlrev_b32 v10, 16, v5
    v_and_b32 v11, 0xffff0000, v5
    v_lshlrev_b32 v12, 16, v6
    v_and_b32 v13, 0xffff0000, v6
    v_lshlrev_b32 v14, 16, v7
    v_and_b32 v15, 0xffff0000, v7
    v_add_f32 v24, v8, v9
    v_add_f32 v24, v24, v10
    v_add_f32 v24, v24, v11
    v_add_f32 v24, v24, v12
    v_add_f32 v24, v24, v13
    v_add_f32 v24, v24, v14
    v_add_f32 v24, v24, v15
    s_nop 1
    v_add_f32_dpp v24, v24, v24 row_ror:8 row_mask:0xf bank_mask:0xf
    s_nop 1
    v_add_f32_dpp v24, v24, v24 row_ror:4 row_mask:0xf bank_mask:0xf
    s_nop 1
    v_add_f32_dpp v24, v24, v24 row_ror:2 row_mask:0xf bank_mask:0xf
    s_nop 1
    v_add_f32_dpp v24, v24, v24 row_ror:1 row_mask:0xf bank_mask:0xf
    s_nop 1
    v_mov_b32 v25, v24
    s_nop 1
    v_permlane16_swap_b32 v24, v25
    s_nop 1
    v_add_f32 v24, v24, v25
    s_nop 1
    v_mov_b32 v25, v24
    s_nop 1
    v_permlane32_swap_b32 v24, v25
    s_nop 1
    v_add_f32 v24, v24, v25
    s_nop 1
    v_mul_f32 v24, 0x3b000000, v24
    v_sub_f32 v16, v8, v24
    v_sub_f32 v17, v9, v24
    v_sub_f32 v18, v10, v24
    v_sub_f32 v19, v11, v24
    v_sub_f32 v20, v12, v24
    v_sub_f32 v21, v13, v24
    v_sub_f32 v22, v14, v24
    v_sub_f32 v23, v15, v24
    v_mul_f32 v26, v16, v16
    v_fmac_f32 v26, v17, v17
    v_fmac_f32 v26, v18, v18
    v_fmac_f32 v26, v19, v19
    v_fmac_f32 v26, v20, v20
    v_fmac_f32 v26, v21, v21
    v_fmac_f32 v26, v22, v22
    v_fmac_f32 v26, v23, v23
    s_nop 1
    s_nop 1
    v_add_f32_dpp v26, v26, v26 row_ror:8 row_mask:0xf bank_mask:0xf
    s_nop 1
    v_add_f32_dpp v26, v26, v26 row_ror:4 row_mask:0xf bank_mask:0xf
    s_nop 1
    v_add_f32_dpp v26, v26, v26 row_ror:2 row_mask:0xf bank_mask:0xf
    s_nop 1
    v_add_f32_dpp v26, v26, v26 row_ror:1 row_mask:0xf bank_mask:0xf
    s_nop 1
    v_mov_b32 v25, v26
    s_nop 1
    v_permlane16_swap_b32 v26, v25
    s_nop 1
    v_add_f32 v26, v26, v25
    s_nop 1
    v_mov_b32 v25, v26
    s_nop 1
    v_permlane32_swap_b32 v26, v25
    s_nop 1
    v_add_f32 v26, v26, v25
    s_nop 1
    v_mul_f32 v26, 0x3b000000, v26
    v_cvt_pk_bf16_f32 v25, v26, v26
    v_lshlrev_b32 v26, 16, v25
    v_cvt_pk_bf16_f32 v25, v24, v24
    v_lshlrev_b32 v24, 16, v25
    v_add_f32 v26, 0x3727c5ac, v26
    v_cvt_pk_bf16_f32 v25, v26, v26
    v_lshlrev_b32 v26, 16, v25
    v_sqrt_f32 v26, v26
    s_nop 0
    v_cvt_pk_bf16_f32 v25, v26, v26
    v_lshlrev_b32 v26, 16, v25
    v_rcp_f32 v27, v26
    s_nop 0
    v_sub_f32 v16, v8, v24
    v_cvt_pk_bf16_f32 v25, v16, v16
    v_lshlrev_b32 v16, 16, v25
    v_mul_f32 v44, v16, v27
    v_fma_f32 v45, -v44, v26, v16
    v_fma_f32 v16, v45, v27, v44
    v_cvt_pk_bf16_f32 v25, v16, v16
    v_lshlrev_b32 v16, 16, v25
    v_sub_f32 v17, v9, v24
    v_cvt_pk_bf16_f32 v25, v17, v17
    v_lshlrev_b32 v17, 16, v25
    v_mul_f32 v44, v17, v27
    v_fma_f32 v45, -v44, v26, v17
    v_fma_f32 v17, v45, v27, v44
    v_cvt_pk_bf16_f32 v25, v17, v17
    v_lshlrev_b32 v17, 16, v25
    v_sub_f32 v18, v10, v24
    v_cvt_pk_bf16_f32 v25, v18, v18
    v_lshlrev_b32 v18, 16, v25
    v_mul_f32 v44, v18, v27
    v_fma_f32 v45, -v44, v26, v18
    v_fma_f32 v18, v45, v27, v44
    v_cvt_pk_bf16_f32 v25, v18, v18
    v_lshlrev_b32 v18, 16, v25
    v_sub_f32 v19, v11, v24
    v_cvt_pk_bf16_f32 v25, v19, v19
    v_lshlrev_b32 v19, 16, v25
    v_mul_f32 v44, v19, v27
    v_fma_f32 v45, -v44, v26, v19
    v_fma_f32 v19, v45, v27, v44
    v_cvt_pk_bf16_f32 v25, v19, v19
    v_lshlrev_b32 v19, 16, v25
    v_sub_f32 v20, v12, v24
    v_cvt_pk_bf16_f32 v25, v20, v20
    v_lshlrev_b32 v20, 16, v25
    v_mul_f32 v44, v20, v27
    v_fma_f32 v45, -v44, v26, v20
    v_fma_f32 v20, v45, v27, v44
    v_cvt_pk_bf16_f32 v25, v20, v20
    v_lshlrev_b32 v20, 16, v25
    v_sub_f32 v21, v13, v24
    v_cvt_pk_bf16_f32 v25, v21, v21
    v_lshlrev_b32 v21, 16, v25
    v_mul_f32 v44, v21, v27
    v_fma_f32 v45, -v44, v26, v21
    v_fma_f32 v21, v45, v27, v44
    v_cvt_pk_bf16_f32 v25, v21, v21
    v_lshlrev_b32 v21, 16, v25
    v_sub_f32 v22, v14, v24
    v_cvt_pk_bf16_f32 v25, v22, v22
    v_lshlrev_b32 v22, 16, v25
    v_mul_f32 v44, v22, v27
    v_fma_f32 v45, -v44, v26, v22
    v_fma_f32 v22, v45, v27, v44
    v_cvt_pk_bf16_f32 v25, v22, v22
    v_lshlrev_b32 v22, 16, v25
    v_sub_f32 v23, v15, v24
    v_cvt_pk_bf16_f32 v25, v23, v23
    v_lshlrev_b32 v23, 16, v25
    v_mul_f32 v44, v23, v27
    v_fma_f32 v45, -v44, v26, v23
    v_fma_f32 v23, v45, v27, v44
    v_cvt_pk_bf16_f32 v25, v23, v23
    v_lshlrev_b32 v23, 16, v25
    v_lshlrev_b32 v3, 5, v1
    ds_write_b128 v3, v[16:19] offset:0
    ds_write_b128 v3, v[20:23] offset:16
    s_waitcnt lgkmcnt(0)
    s_barrier
    s_cmp_lg_u32 s14, 0
    s_cbranch_scc1 L_CS_SKIP
    s_mov_b64 exec, 1
    v_mov_b32 v3, 128
    v_mov_b32 v24, 1
    buffer_atomic_add v24, v3, s[40:43], 0 offen
    s_mov_b64 exec, -1
L_CS_SKIP:
    v_lshrrev_b32 v3, 4, v0
    v_lshlrev_b32 v3, 2, v3
    ds_read_b32 v4, v3 offset:0
    ds_read_b32 v5, v3 offset:256
    ds_read_b32 v6, v3 offset:512
    ds_read_b32 v7, v3 offset:768
    ds_read_b32 v8, v3 offset:1024
    ds_read_b32 v9, v3 offset:1280
    ds_read_b32 v10, v3 offset:1536
    ds_read_b32 v11, v3 offset:1792
    s_waitcnt vmcnt(16) lgkmcnt(0)
    v_lshlrev_b32 v20, 16, v48
    v_and_b32 v21, 0xffff0000, v48
    v_lshlrev_b32 v22, 16, v49
    v_and_b32 v23, 0xffff0000, v49
    v_lshlrev_b32 v24, 16, v50
    v_and_b32 v25, 0xffff0000, v50
    v_lshlrev_b32 v26, 16, v51
    v_and_b32 v27, 0xffff0000, v51
    v_pk_mul_f32 v[12:13], v[20:21], v[4:5] op_sel_hi:[1,0]
    v_pk_mul_f32 v[14:15], v[22:23], v[4:5] op_sel_hi:[1,0]
    v_pk_mul_f32 v[16:17], v[24:25], v[4:5] op_sel_hi:[1,0]
    v_pk_mul_f32 v[18:19], v[26:27], v[4:5] op_sel_hi:[1,0]
    v_lshlrev_b32 v20, 16, v52
    v_and_b32 v21, 0xffff0000, v52
    v_lshlrev_b32 v22, 16, v53
    v_and_b32 v23, 0xffff0000, v53
    v_lshlrev_b32 v24, 16, v54
    v_and_b32 v25, 0xffff0000, v54
    v_lshlrev_b32 v26, 16, v55
    v_and_b32 v27, 0xffff0000, v55
    v_pk_fma_f32 v[12:13], v[20:21], v[4:5], v[12:13] op_sel:[0,1,0] op_sel_hi:[1,1,1]
    v_pk_fma_f32 v[14:15], v[22:23], v[4:5], v[14:15] op_sel:[0,1,0] op_sel_hi:[1,1,1]
    v_pk_fma_f32 v[16:17], v[24:25], v[4:5], v[16:17] op_sel:[0,1,0] op_sel_hi:[1,1,1]
    v_pk_fma_f32 v[18:19], v[26:27], v[4:5], v[18:19] op_sel:[0,1,0] op_sel_hi:[1,1,1]
    v_lshlrev_b32 v20, 16, v56
    v_and_b32 v21, 0xffff0000, v56
    v_lshlrev_b32 v22, 16, v57
    v_and_b32 v23, 0xffff0000, v57
    v_lshlrev_b32 v24, 16, v58
    v_and_b32 v25, 0xffff0000, v58
    v_lshlrev_b32 v26, 16, v59
    v_and_b32 v27, 0xffff0000, v59
    v_pk_fma_f32 v[12:13], v[20:21], v[6:7], v[12:13] op_sel_hi:[1,0,1]
    v_pk_fma_f32 v[14:15], v[22:23], v[6:7], v[14:15] op_sel_hi:[1,0,1]
    v_pk_fma_f32 v[16:17], v[24:25], v[6:7], v[16:17] op_sel_hi:[1,0,1]
    v_pk_fma_f32 v[18:19], v[26:27], v[6:7], v[18:19] op_sel_hi:[1,0,1]
    v_lshlrev_b32 v20, 16, v60
    v_and_b32 v21, 0xffff0000, v60
    v_lshlrev_b32 v22, 16, v61
    v_and_b32 v23, 0xffff0000, v61
    v_lshlrev_b32 v24, 16, v62
    v_and_b32 v25, 0xffff0000, v62
    v_lshlrev_b32 v26, 16, v63
    v_and_b32 v27, 0xffff0000, v63
    v_pk_fma_f32 v[12:13], v[20:21], v[6:7], v[12:13] op_sel:[0,1,0] op_sel_hi:[1,1,1]
    v_pk_fma_f32 v[14:15], v[22:23], v[6:7], v[14:15] op_sel:[0,1,0] op_sel_hi:[1,1,1]
    v_pk_fma_f32 v[16:17], v[24:25], v[6:7], v[16:17] op_sel:[0,1,0] op_sel_hi:[1,1,1]
    v_pk_fma_f32 v[18:19], v[26:27], v[6:7], v[18:19] op_sel:[0,1,0] op_sel_hi:[1,1,1]
    v_lshlrev_b32 v20, 16, v28
    v_and_b32 v21, 0xffff0000, v28
    v_lshlrev_b32 v22, 16, v29
    v_and_b32 v23, 0xffff0000, v29
    v_lshlrev_b32 v24, 16, v30
    v_and_b32 v25, 0xffff0000, v30
    v_lshlrev_b32 v26, 16, v31
    v_and_b32 v27, 0xffff0000, v31
    v_pk_fma_f32 v[12:13], v[20:21], v[8:9], v[12:13] op_sel_hi:[1,0,1]
    v_pk_fma_f32 v[14:15], v[22:23], v[8:9], v[14:15] op_sel_hi:[1,0,1]
    v_pk_fma_f32 v[16:17], v[24:25], v[8:9], v[16:17] op_sel_hi:[1,0,1]
    v_pk_fma_f32 v[18:19], v[26:27], v[8:9], v[18:19] op_sel_hi:[1,0,1]
    v_lshlrev_b32 v20, 16, v32
    v_and_b32 v21, 0xffff0000, v32
    v_lshlrev_b32 v22, 16, v33
    v_and_b32 v23, 0xffff0000, v33
    v_lshlrev_b32 v24, 16, v34
    v_and_b32 v25, 0xffff0000, v34
    v_lshlrev_b32 v26, 16, v35
    v_and_b32 v27, 0xffff0000, v35
    v_pk_fma_f32 v[12:13], v[20:21], v[8:9], v[12:13] op_sel:[0,1,0] op_sel_hi:[1,1,1]
    v_pk_fma_f32 v[14:15], v[22:23], v[8:9], v[14:15] op_sel:[0,1,0] op_sel_hi:[1,1,1]
    v_pk_fma_f32 v[16:17], v[24:25], v[8:9], v[16:17] op_sel:[0,1,0] op_sel_hi:[1,1,1]
    v_pk_fma_f32 v[18:19], v[26:27], v[8:9], v[18:19] op_sel:[0,1,0] op_sel_hi:[1,1,1]
    v_lshlrev_b32 v20, 16, v36
    v_and_b32 v21, 0xffff0000, v36
    v_lshlrev_b32 v22, 16, v37
    v_and_b32 v23, 0xffff0000, v37
    v_lshlrev_b32 v24, 16, v38
    v_and_b32 v25, 0xffff0000, v38
    v_lshlrev_b32 v26, 16, v39
    v_and_b32 v27, 0xffff0000, v39
    v_pk_fma_f32 v[12:13], v[20:21], v[10:11], v[12:13] op_sel_hi:[1,0,1]
    v_pk_fma_f32 v[14:15], v[22:23], v[10:11], v[14:15] op_sel_hi:[1,0,1]
    v_pk_fma_f32 v[16:17], v[24:25], v[10:11], v[16:17] op_sel_hi:[1,0,1]
    v_pk_fma_f32 v[18:19], v[26:27], v[10:11], v[18:19] op_sel_hi:[1,0,1]
    v_lshlrev_b32 v20, 16, v40
    v_and_b32 v21, 0xffff0000, v40
    v_lshlrev_b32 v22, 16, v41
    v_and_b32 v23, 0xffff0000, v41
    v_lshlrev_b32 v24, 16, v42
    v_and_b32 v25, 0xffff0000, v42
    v_lshlrev_b32 v26, 16, v43
    v_and_b32 v27, 0xffff0000, v43
    v_pk_fma_f32 v[12:13], v[20:21], v[10:11], v[12:13] op_sel:[0,1,0] op_sel_hi:[1,1,1]
    v_pk_fma_f32 v[14:15], v[22:23], v[10:11], v[14:15] op_sel:[0,1,0] op_sel_hi:[1,1,1]
    v_pk_fma_f32 v[16:17], v[24:25], v[10:11], v[16:17] op_sel:[0,1,0] op_sel_hi:[1,1,1]
    v_pk_fma_f32 v[18:19], v[26:27], v[10:11], v[18:19] op_sel:[0,1,0] op_sel_hi:[1,1,1]
    s_nop 1
    v_mov_b32 v20, v12
    v_mov_b32 v21, v13
    v_mov_b32 v22, v14
    v_mov_b32 v23, v15
    v_mov_b32 v24, v16
    v_mov_b32 v25, v17
    v_mov_b32 v26, v18
    v_mov_b32 v27, v19
    s_nop 1
    v_permlane16_swap_b32 v12, v20
    v_permlane16_swap_b32 v13, v21
    v_permlane16_swap_b32 v14, v22
    v_permlane16_swap_b32 v15, v23
    v_permlane16_swap_b32 v16, v24
    v_permlane16_swap_b32 v17, v25
    v_permlane16_swap_b32 v18, v26
    v_permlane16_swap_b32 v19, v27
    s_nop 1
    v_add_f32 v12, v12, v20
    v_add_f32 v13, v13, v21
    v_add_f32 v14, v14, v22
    v_add_f32 v15, v15, v23
    v_add_f32 v16, v16, v24
    v_add_f32 v17, v17, v25
    v_add_f32 v18, v18, v26
    v_add_f32 v19, v19, v27
    s_nop 1
    v_mov_b32 v20, v12
    v_mov_b32 v21, v13
    v_mov_b32 v22, v14
    v_mov_b32 v23, v15
    v_mov_b32 v24, v16
    v_mov_b32 v25, v17
    v_mov_b32 v26, v18
    v_mov_b32 v27, v19
    s_nop 1
    v_permlane32_swap_b32 v12, v20
    v_permlane32_swap_b32 v13, v21
    v_permlane32_swap_b32 v14, v22
    v_permlane32_swap_b32 v15, v23
    v_permlane32_swap_b32 v16, v24
    v_permlane32_swap_b32 v17, v25
    v_permlane32_swap_b32 v18, v26
    v_permlane32_swap_b32 v19, v27
    s_nop 1
    v_add_f32 v12, v12, v20
    v_add_f32 v13, v13, v21
    v_add_f32 v14, v14, v22
    v_add_f32 v15, v15, v23
    v_add_f32 v16, v16, v24
    v_add_f32 v17, v17, v25
    v_add_f32 v18, v18, v26
    v_add_f32 v19, v19, v27
    s_nop 1
    v_lshlrev_b32 v3, 9, v2
    v_and_b32 v20, 15, v0
    v_lshl_add_u32 v3, v20, 5, v3
    ds_write_b128 v3, v[12:15] offset:2048
    ds_write_b128 v3, v[16:19] offset:2064
    s_waitcnt lgkmcnt(0)
    s_barrier
    s_cmp_ge_u32 s14, 2
    s_cbranch_scc1 L_QSKIP
    v_lshlrev_b32 v3, 2, v0
    ds_read_b32 v16, v3 offset:2048
    ds_read_b32 v17, v3 offset:2560
    ds_read_b32 v18, v3 offset:3072
    ds_read_b32 v19, v3 offset:3584
    ds_read_b32 v20, v3 offset:4096
    ds_read_b32 v21, v3 offset:4608
    ds_read_b32 v22, v3 offset:5120
    ds_read_b32 v23, v3 offset:5632
    ds_read_b32 v24, v3 offset:6144
    ds_read_b32 v25, v3 offset:6656
    ds_read_b32 v26, v3 offset:7168
    ds_read_b32 v27, v3 offset:7680
    ds_read_b32 v28, v3 offset:8192
    ds_read_b32 v29, v3 offset:8704
    ds_read_b32 v30, v3 offset:9216
    ds_read_b32 v31, v3 offset:9728
    s_waitcnt lgkmcnt(0)
    v_add_f32 v16, v16, v17
    v_add_f32 v16, v16, v18
    v_add_f32 v16, v16, v19
    v_add_f32 v16, v16, v20
    v_add_f32 v16, v16, v21
    v_add_f32 v16, v16, v22
    v_add_f32 v16, v16, v23
    v_add_f32 v16, v16, v24
    v_add_f32 v16, v16, v25
    v_add_f32 v16, v16, v26
    v_add_f32 v16, v16, v27
    v_add_f32 v16, v16, v28
    v_add_f32 v16, v16, v29
    v_add_f32 v16, v16, v30
    v_add_f32 v16, v16, v31
    v_cvt_pk_bf16_f32 v16, v16, v16
    v_lshlrev_b32 v3, 1, v0
    ds_write_b16 v3, v16 offset:10240
    s_waitcnt lgkmcnt(0)
L_QSKIP:
    s_barrier
    v_and_b32 v3, 15, v0
    v_lshlrev_b32 v3, 4, v3
    ds_read_b128 v[4:7], v3 offset:10240
    v_mov_b32 v40, 0xff800000
    v_mov_b32 v41, 0
    v_mov_b32 v8, 0
    v_mov_b32 v9, 0
    v_mov_b32 v10, 0
    v_mov_b32 v11, 0
    v_mov_b32 v12, 0
    v_mov_b32 v13, 0
    v_mov_b32 v14, 0
    v_mov_b32 v15, 0
    s_mov_b32 s96, 0x3db504f3
    s_mov_b32 s97, 0x3db504f3
    s_mov_b32 s98, 0x3fb8aa3b
    s_waitcnt lgkmcnt(0)
L_LOOP:
    s_add_u32 s95, s94, 131072
    s_waitcnt vmcnt(8)
    v_dot2_f32_bf16 v16, v64, v4, 0
    v_dot2_f32_bf16 v17, v68, v4, 0
    v_dot2_f32_bf16 v18, v72, v4, 0
    v_dot2_f32_bf16 v19, v76, v4, 0
    v_dot2_f32_bf16 v20, v80, v4, 0
    v_dot2_f32_bf16 v21, v84, v4, 0
    v_dot2_f32_bf16 v22, v88, v4, 0
    v_dot2_f32_bf16 v23, v92, v4, 0
    v_dot2_f32_bf16 v16, v65, v5, v16
    v_dot2_f32_bf16 v17, v69, v5, v17
    v_dot2_f32_bf16 v18, v73, v5, v18
    v_dot2_f32_bf16 v19, v77, v5, v19
    v_dot2_f32_bf16 v20, v81, v5, v20
    v_dot2_f32_bf16 v21, v85, v5, v21
    v_dot2_f32_bf16 v22, v89, v5, v22
    v_dot2_f32_bf16 v23, v93, v5, v23
    v_dot2_f32_bf16 v16, v66, v6, v16
    v_dot2_f32_bf16 v17, v70, v6, v17
    v_dot2_f32_bf16 v18, v74, v6, v18
    v_dot2_f32_bf16 v19, v78, v6, v19
    v_dot2_f32_bf16 v20, v82, v6, v20
    v_dot2_f32_bf16 v21, v86, v6, v21
    v_dot2_f32_bf16 v22, v90, v6, v22
    v_dot2_f32_bf16 v23, v94, v6, v23
    v_dot2_f32_bf16 v16, v67, v7, v16
    v_dot2_f32_bf16 v17, v71, v7, v17
    v_dot2_f32_bf16 v18, v75, v7, v18
    v_dot2_f32_bf16 v19, v79, v7, v19
    v_dot2_f32_bf16 v20, v83, v7, v20
    v_dot2_f32_bf16 v21, v87, v7, v21
    v_dot2_f32_bf16 v22, v91, v7, v22
    v_dot2_f32_bf16 v23, v95, v7, v23
    buffer_load_dwordx4 v[64:67], v46, s[20:23], s95 offen offset:0 nt
    buffer_load_dwordx4 v[68:71], v46, s[20:23], s95 offen offset:1024 nt
    buffer_load_dwordx4 v[72:75], v46, s[20:23], s95 offen offset:2048 nt
    buffer_load_dwordx4 v[76:79], v46, s[20:23], s95 offen offset:3072 nt
    buffer_load_dwordx4 v[80:83], v47, s[20:23], s95 offen offset:0 nt
    buffer_load_dwordx4 v[84:87], v47, s[20:23], s95 offen offset:1024 nt
    buffer_load_dwordx4 v[88:91], v47, s[20:23], s95 offen offset:2048 nt
    buffer_load_dwordx4 v[92:95], v47, s[20:23], s95 offen offset:3072 nt
    v_add_f32_dpp v16, v16, v16 row_ror:8 row_mask:0xf bank_mask:0xf
    v_add_f32_dpp v17, v17, v17 row_ror:8 row_mask:0xf bank_mask:0xf
    v_add_f32_dpp v18, v18, v18 row_ror:8 row_mask:0xf bank_mask:0xf
    v_add_f32_dpp v19, v19, v19 row_ror:8 row_mask:0xf bank_mask:0xf
    v_add_f32_dpp v20, v20, v20 row_ror:8 row_mask:0xf bank_mask:0xf
    v_add_f32_dpp v21, v21, v21 row_ror:8 row_mask:0xf bank_mask:0xf
    v_add_f32_dpp v22, v22, v22 row_ror:8 row_mask:0xf bank_mask:0xf
    v_add_f32_dpp v23, v23, v23 row_ror:8 row_mask:0xf bank_mask:0xf
    v_add_f32_dpp v16, v16, v16 row_ror:4 row_mask:0xf bank_mask:0xf
    v_add_f32_dpp v17, v17, v17 row_ror:4 row_mask:0xf bank_mask:0xf
    v_add_f32_dpp v18, v18, v18 row_ror:4 row_mask:0xf bank_mask:0xf
    v_add_f32_dpp v19, v19, v19 row_ror:4 row_mask:0xf bank_mask:0xf
    v_add_f32_dpp v20, v20, v20 row_ror:4 row_mask:0xf bank_mask:0xf
    v_add_f32_dpp v21, v21, v21 row_ror:4 row_mask:0xf bank_mask:0xf
    v_add_f32_dpp v22, v22, v22 row_ror:4 row_mask:0xf bank_mask:0xf
    v_add_f32_dpp v23, v23, v23 row_ror:4 row_mask:0xf bank_mask:0xf
    v_add_f32_dpp v16, v16, v16 row_ror:2 row_mask:0xf bank_mask:0xf
    v_add_f32_dpp v17, v17, v17 row_ror:2 row_mask:0xf bank_mask:0xf
    v_add_f32_dpp v18, v18, v18 row_ror:2 row_mask:0xf bank_mask:0xf
    v_add_f32_dpp v19, v19, v19 row_ror:2 row_mask:0xf bank_mask:0xf
    v_add_f32_dpp v20, v20, v20 row_ror:2 row_mask:0xf bank_mask:0xf
    v_add_f32_dpp v21, v21, v21 row_ror:2 row_mask:0xf bank_mask:0xf
    v_add_f32_dpp v22, v22, v22 row_ror:2 row_mask:0xf bank_mask:0xf
    v_add_f32_dpp v23, v23, v23 row_ror:2 row_mask:0xf bank_mask:0xf
    v_add_f32_dpp v16, v16, v16 row_ror:1 row_mask:0xf bank_mask:0xf
    v_add_f32_dpp v17, v17, v17 row_ror:1 row_mask:0xf bank_mask:0xf
    v_add_f32_dpp v18, v18, v18 row_ror:1 row_mask:0xf bank_mask:0xf
    v_add_f32_dpp v19, v19, v19 row_ror:1 row_mask:0xf bank_mask:0xf
    v_add_f32_dpp v20, v20, v20 row_ror:1 row_mask:0xf bank_mask:0xf
    v_add_f32_dpp v21, v21, v21 row_ror:1 row_mask:0xf bank_mask:0xf
    v_add_f32_dpp v22, v22, v22 row_ror:1 row_mask:0xf bank_mask:0xf
    v_add_f32_dpp v23, v23, v23 row_ror:1 row_mask:0xf bank_mask:0xf
    s_nop 1
    v_cvt_pk_bf16_f32 v32, v16, v17
    v_cvt_pk_bf16_f32 v34, v18, v19
    v_cvt_pk_bf16_f32 v36, v20, v21
    v_cvt_pk_bf16_f32 v38, v22, v23
    v_lshlrev_b32 v16, 16, v32
    v_and_b32 v17, 0xffff0000, v32
    v_lshlrev_b32 v18, 16, v34
    v_and_b32 v19, 0xffff0000, v34
    v_lshlrev_b32 v20, 16, v36
    v_and_b32 v21, 0xffff0000, v36
    v_lshlrev_b32 v22, 16, v38
    v_and_b32 v23, 0xffff0000, v38
    v_pk_mul_f32 v[16:17], v[16:17], s[96:97]
    v_pk_mul_f32 v[18:19], v[18:19], s[96:97]
    v_pk_mul_f32 v[20:21], v[20:21], s[96:97]
    v_pk_mul_f32 v[22:23], v[22:23], s[96:97]
    v_cvt_pk_bf16_f32 v32, v16, v17
    v_cvt_pk_bf16_f32 v34, v18, v19
    v_cvt_pk_bf16_f32 v36, v20, v21
    v_cvt_pk_bf16_f32 v38, v22, v23
    v_lshlrev_b32 v16, 16, v32
    v_and_b32 v17, 0xffff0000, v32
    v_lshlrev_b32 v18, 16, v34
    v_and_b32 v19, 0xffff0000, v34
    v_lshlrev_b32 v20, 16, v36
    v_and_b32 v21, 0xffff0000, v36
    v_lshlrev_b32 v22, 16, v38
    v_and_b32 v23, 0xffff0000, v38
    v_max3_f32 v42, v16, v17, v40
    v_max3_f32 v32, v18, v19, v20
    v_max3_f32 v33, v21, v22, v23
    v_max3_f32 v42, v42, v32, v33
    v_mul_f32 v34, s98, v42
    v_fma_f32 v44, v40, s98, -v34
    v_exp_f32 v44, v44
    v_fma_f32 v24, v16, s98, -v34
    v_fma_f32 v25, v17, s98, -v34
    v_fma_f32 v26, v18, s98, -v34
    v_fma_f32 v27, v19, s98, -v34
    v_fma_f32 v28, v20, s98, -v34
    v_fma_f32 v29, v21, s98, -v34
    v_fma_f32 v30, v22, s98, -v34
    v_fma_f32 v31, v23, s98, -v34
    v_exp_f32 v24, v24
    v_exp_f32 v25, v25
    v_exp_f32 v26, v26
    v_exp_f32 v27, v27
    v_exp_f32 v28, v28
    v_exp_f32 v29, v29
    v_exp_f32 v30, v30
    v_exp_f32 v31, v31
    v_mov_b32 v45, v44
    v_mov_b32 v40, v42
    v_mul_f32 v41, v41, v44
    v_pk_mul_f32 v[8:9], v[8:9], v[44:45]
    v_pk_mul_f32 v[10:11], v[10:11], v[44:45]
    v_pk_mul_f32 v[12:13], v[12:13], v[44:45]
    v_pk_mul_f32 v[14:15], v[14:15], v[44:45]
    v_add_f32 v41, v41, v24
    v_add_f32 v41, v41, v25
    v_add_f32 v41, v41, v26
    v_add_f32 v41, v41, v27
    v_add_f32 v41, v41, v28
    v_add_f32 v41, v41, v29
    v_add_f32 v41, v41, v30
    v_add_f32 v41, v41, v31
    s_waitcnt vmcnt(8)
    v_lshlrev_b32 v32, 16, v96
    v_and_b32 v33, 0xffff0000, v96
    v_lshlrev_b32 v34, 16, v97
    v_and_b32 v35, 0xffff0000, v97
    v_lshlrev_b32 v36, 16, v98
    v_and_b32 v37, 0xffff0000, v98
    v_lshlrev_b32 v38, 16, v99
    v_and_b32 v39, 0xffff0000, v99
    v_pk_fma_f32 v[8:9], v[32:33], v[24:25], v[8:9] op_sel_hi:[1,0,1]
    v_pk_fma_f32 v[10:11], v[34:35], v[24:25], v[10:11] op_sel_hi:[1,0,1]
    v_pk_fma_f32 v[12:13], v[36:37], v[24:25], v[12:13] op_sel_hi:[1,0,1]
    v_pk_fma_f32 v[14:15], v[38:39], v[24:25], v[14:15] op_sel_hi:[1,0,1]
    v_lshlrev_b32 v32, 16, v100
    v_and_b32 v33, 0xffff0000, v100
    v_lshlrev_b32 v34, 16, v101
    v_and_b32 v35, 0xffff0000, v101
    v_lshlrev_b32 v36, 16, v102
    v_and_b32 v37, 0xffff0000, v102
    v_lshlrev_b32 v38, 16, v103
    v_and_b32 v39, 0xffff0000, v103
    v_pk_fma_f32 v[8:9], v[32:33], v[24:25], v[8:9] op_sel:[0,1,0] op_sel_hi:[1,1,1]
    v_pk_fma_f32 v[10:11], v[34:35], v[24:25], v[10:11] op_sel:[0,1,0] op_sel_hi:[1,1,1]
    v_pk_fma_f32 v[12:13], v[36:37], v[24:25], v[12:13] op_sel:[0,1,0] op_sel_hi:[1,1,1]
    v_pk_fma_f32 v[14:15], v[38:39], v[24:25], v[14:15] op_sel:[0,1,0] op_sel_hi:[1,1,1]
    v_lshlrev_b32 v32, 16, v104
    v_and_b32 v33, 0xffff0000, v104
    v_lshlrev_b32 v34, 16, v105
    v_and_b32 v35, 0xffff0000, v105
    v_lshlrev_b32 v36, 16, v106
    v_and_b32 v37, 0xffff0000, v106
    v_lshlrev_b32 v38, 16, v107
    v_and_b32 v39, 0xffff0000, v107
    v_pk_fma_f32 v[8:9], v[32:33], v[26:27], v[8:9] op_sel_hi:[1,0,1]
    v_pk_fma_f32 v[10:11], v[34:35], v[26:27], v[10:11] op_sel_hi:[1,0,1]
    v_pk_fma_f32 v[12:13], v[36:37], v[26:27], v[12:13] op_sel_hi:[1,0,1]
    v_pk_fma_f32 v[14:15], v[38:39], v[26:27], v[14:15] op_sel_hi:[1,0,1]
    v_lshlrev_b32 v32, 16, v108
    v_and_b32 v33, 0xffff0000, v108
    v_lshlrev_b32 v34, 16, v109
    v_and_b32 v35, 0xffff0000, v109
    v_lshlrev_b32 v36, 16, v110
    v_and_b32 v37, 0xffff0000, v110
    v_lshlrev_b32 v38, 16, v111
    v_and_b32 v39, 0xffff0000, v111
    v_pk_fma_f32 v[8:9], v[32:33], v[26:27], v[8:9] op_sel:[0,1,0] op_sel_hi:[1,1,1]
    v_pk_fma_f32 v[10:11], v[34:35], v[26:27], v[10:11] op_sel:[0,1,0] op_sel_hi:[1,1,1]
    v_pk_fma_f32 v[12:13], v[36:37], v[26:27], v[12:13] op_sel:[0,1,0] op_sel_hi:[1,1,1]
    v_pk_fma_f32 v[14:15], v[38:39], v[26:27], v[14:15] op_sel:[0,1,0] op_sel_hi:[1,1,1]
    v_lshlrev_b32 v32, 16, v112
    v_and_b32 v33, 0xffff0000, v112
    v_lshlrev_b32 v34, 16, v113
    v_and_b32 v35, 0xffff0000, v113
    v_lshlrev_b32 v36, 16, v114
    v_and_b32 v37, 0xffff0000, v114
    v_lshlrev_b32 v38, 16, v115
    v_and_b32 v39, 0xffff0000, v115
    v_pk_fma_f32 v[8:9], v[32:33], v[28:29], v[8:9] op_sel_hi:[1,0,1]
    v_pk_fma_f32 v[10:11], v[34:35], v[28:29], v[10:11] op_sel_hi:[1,0,1]
    v_pk_fma_f32 v[12:13], v[36:37], v[28:29], v[12:13] op_sel_hi:[1,0,1]
    v_pk_fma_f32 v[14:15], v[38:39], v[28:29], v[14:15] op_sel_hi:[1,0,1]
    v_lshlrev_b32 v32, 16, v116
    v_and_b32 v33, 0xffff0000, v116
    v_lshlrev_b32 v34, 16, v117
    v_and_b32 v35, 0xffff0000, v117
    v_lshlrev_b32 v36, 16, v118
    v_and_b32 v37, 0xffff0000, v118
    v_lshlrev_b32 v38, 16, v119
    v_and_b32 v39, 0xffff0000, v119
    v_pk_fma_f32 v[8:9], v[32:33], v[28:29], v[8:9] op_sel:[0,1,0] op_sel_hi:[1,1,1]
    v_pk_fma_f32 v[10:11], v[34:35], v[28:29], v[10:11] op_sel:[0,1,0] op_sel_hi:[1,1,1]
    v_pk_fma_f32 v[12:13], v[36:37], v[28:29], v[12:13] op_sel:[0,1,0] op_sel_hi:[1,1,1]
    v_pk_fma_f32 v[14:15], v[38:39], v[28:29], v[14:15] op_sel:[0,1,0] op_sel_hi:[1,1,1]
    v_lshlrev_b32 v32, 16, v120
    v_and_b32 v33, 0xffff0000, v120
    v_lshlrev_b32 v34, 16, v121
    v_and_b32 v35, 0xffff0000, v121
    v_lshlrev_b32 v36, 16, v122
    v_and_b32 v37, 0xffff0000, v122
    v_lshlrev_b32 v38, 16, v123
    v_and_b32 v39, 0xffff0000, v123
    v_pk_fma_f32 v[8:9], v[32:33], v[30:31], v[8:9] op_sel_hi:[1,0,1]
    v_pk_fma_f32 v[10:11], v[34:35], v[30:31], v[10:11] op_sel_hi:[1,0,1]
    v_pk_fma_f32 v[12:13], v[36:37], v[30:31], v[12:13] op_sel_hi:[1,0,1]
    v_pk_fma_f32 v[14:15], v[38:39], v[30:31], v[14:15] op_sel_hi:[1,0,1]
    v_lshlrev_b32 v32, 16, v124
    v_and_b32 v33, 0xffff0000, v124
    v_lshlrev_b32 v34, 16, v125
    v_and_b32 v35, 0xffff0000, v125
    v_lshlrev_b32 v36, 16, v126
    v_and_b32 v37, 0xffff0000, v126
    v_lshlrev_b32 v38, 16, v127
    v_and_b32 v39, 0xffff0000, v127
    v_pk_fma_f32 v[8:9], v[32:33], v[30:31], v[8:9] op_sel:[0,1,0] op_sel_hi:[1,1,1]
    v_pk_fma_f32 v[10:11], v[34:35], v[30:31], v[10:11] op_sel:[0,1,0] op_sel_hi:[1,1,1]
    v_pk_fma_f32 v[12:13], v[36:37], v[30:31], v[12:13] op_sel:[0,1,0] op_sel_hi:[1,1,1]
    v_pk_fma_f32 v[14:15], v[38:39], v[30:31], v[14:15] op_sel:[0,1,0] op_sel_hi:[1,1,1]
    buffer_load_dwordx4 v[96:99], v46, s[24:27], s95 offen offset:0 nt
    buffer_load_dwordx4 v[100:103], v46, s[24:27], s95 offen offset:1024 nt
    buffer_load_dwordx4 v[104:107], v46, s[24:27], s95 offen offset:2048 nt
    buffer_load_dwordx4 v[108:111], v46, s[24:27], s95 offen offset:3072 nt
    buffer_load_dwordx4 v[112:115], v47, s[24:27], s95 offen offset:0 nt
    buffer_load_dwordx4 v[116:119], v47, s[24:27], s95 offen offset:1024 nt
    buffer_load_dwordx4 v[120:123], v47, s[24:27], s95 offen offset:2048 nt
    buffer_load_dwordx4 v[124:127], v47, s[24:27], s95 offen offset:3072 nt
    s_mov_b32 s94, s95
    s_cmp_lt_u32 s94, 1048576
    s_cbranch_scc1 L_LOOP
    s_cmp_ge_u32 s14, 4
    s_cbranch_scc1 L_WLOAD_SKIP
    v_lshrrev_b32 v3, 2, v0
    v_lshlrev_b32 v3, 10, v3
    v_and_b32 v32, 3, v0
    v_lshl_add_u32 v3, v32, 4, v3
    s_mov_b32 s93, 0
    buffer_load_dwordx4 v[64:67], v3, s[44:47], s93 offen
    s_mov_b32 s93, 65536
    buffer_load_dwordx4 v[68:71], v3, s[44:47], s93 offen
    s_mov_b32 s93, 131072
    buffer_load_dwordx4 v[72:75], v3, s[44:47], s93 offen
    s_mov_b32 s93, 196608
    buffer_load_dwordx4 v[76:79], v3, s[44:47], s93 offen
    v_lshrrev_b32 v3, 1, v0
    s_movk_i32 s93, 3584
    v_mul_lo_u32 v3, v3, s93
    s_mov_b32 s92, 0x55555555
    s_mov_b32 s93, 0x55555555
    s_mov_b64 exec, s[92:93]
    s_mov_b32 s99, 0
    buffer_load_dwordx4 v[80:83], v3, s[48:51], s99 offen
    s_mov_b32 s99, 458752
    buffer_load_dwordx4 v[84:87], v3, s[48:51], s99 offen
    s_mov_b32 s99, 917504
    buffer_load_dwordx4 v[88:91], v3, s[48:51], s99 offen
    s_mov_b32 s99, 1376256
    buffer_load_dwordx4 v[92:95], v3, s[48:51], s99 offen
    s_not_b64 exec, exec
    s_mov_b32 s99, 0
    buffer_load_dwordx4 v[80:83], v3, s[52:55], s99 offen
    s_mov_b32 s99, 458752
    buffer_load_dwordx4 v[84:87], v3, s[52:55], s99 offen
    s_mov_b32 s99, 917504
    buffer_load_dwordx4 v[88:91], v3, s[52:55], s99 offen
    s_mov_b32 s99, 1376256
    buffer_load_dwordx4 v[92:95], v3, s[52:55], s99 offen
    s_mov_b64 exec, -1
    v_lshlrev_b32 v3, 10, v0
    s_mov_b32 s93, 0
    buffer_load_dwordx4 v[96:99], v3, s[56:59], s93 offen
    s_mov_b32 s93, 262144
    buffer_load_dwordx4 v[100:103], v3, s[56:59], s93 offen
    s_mov_b32 s93, 524288
    buffer_load_dwordx4 v[104:107], v3, s[56:59], s93 offen
    s_mov_b32 s93, 786432
    buffer_load_dwordx4 v[108:111], v3, s[56:59], s93 offen
    s_mov_b32 s93, 1048576
    buffer_load_dwordx4 v[112:115], v3, s[56:59], s93 offen
    s_mov_b32 s93, 1310720
    buffer_load_dwordx4 v[116:119], v3, s[56:59], s93 offen
    s_mov_b32 s93, 1572864
    buffer_load_dwordx4 v[120:123], v3, s[56:59], s93 offen
L_WLOAD_SKIP:
    v_lshrrev_b32 v3, 4, v0
    v_lshlrev_b32 v44, 9, v3
    v_and_b32 v45, 15, v0
    v_lshl_add_u32 v44, v45, 5, v44
    ds_write_b128 v44, v[8:11] offset:11008
    ds_write_b128 v44, v[12:15] offset:11024
    v_lshlrev_b32 v3, 2, v3
    ds_write_b32 v3, v40 offset:10496
    ds_write_b32 v3, v41 offset:10752
    s_waitcnt lgkmcnt(0)
    s_barrier
    v_lshlrev_b32 v3, 4, v45
    ds_read_b128 v[8:11], v3 offset:10496
    v_and_b32 v40, 127, v0
    v_lshrrev_b32 v41, 7, v0
    v_lshlrev_b32 v44, 5, v41
    ds_read_b128 v[16:19], v44 offset:10496
    ds_read_b128 v[20:23], v44 offset:10512
    ds_read_b128 v[24:27], v44 offset:10752
    ds_read_b128 v[28:31], v44 offset:10768
    v_lshlrev_b32 v44, 12, v41
    v_lshl_add_u32 v44, v40, 2, v44
    ds_read_b32 v32, v44 offset:11008
    ds_read_b32 v33, v44 offset:11520
    ds_read_b32 v34, v44 offset:12032
    ds_read_b32 v35, v44 offset:12544
    ds_read_b32 v36, v44 offset:13056
    ds_read_b32 v37, v44 offset:13568
    ds_read_b32 v38, v44 offset:14080
    ds_read_b32 v39, v44 offset:14592
    s_waitcnt lgkmcnt(0)
    v_max3_f32 v42, v8, v9, v10
    v_max_f32 v42, v42, v11
    s_nop 1
    v_max_f32_dpp v42, v42, v42 row_ror:8 row_mask:0xf bank_mask:0xf
    s_nop 1
    v_max_f32_dpp v42, v42, v42 row_ror:4 row_mask:0xf bank_mask:0xf
    s_nop 1
    v_max_f32_dpp v42, v42, v42 row_ror:2 row_mask:0xf bank_mask:0xf
    s_nop 1
    v_max_f32_dpp v42, v42, v42 row_ror:1 row_mask:0xf bank_mask:0xf
    s_nop 1
    v_mul_f32 v8, s98, v42
    v_fma_f32 v16, v16, s98, -v8
    v_fma_f32 v17, v17, s98, -v8
    v_fma_f32 v18, v18, s98, -v8
    v_fma_f32 v19, v19, s98, -v8
    v_fma_f32 v20, v20, s98, -v8
    v_fma_f32 v21, v21, s98, -v8
    v_fma_f32 v22, v22, s98, -v8
    v_fma_f32 v23, v23, s98, -v8
    v_exp_f32 v16, v16
    v_exp_f32 v17, v17
    v_exp_f32 v18, v18
    v_exp_f32 v19, v19
    v_exp_f32 v20, v20
    v_exp_f32 v21, v21
    v_exp_f32 v22, v22
    v_exp_f32 v23, v23
    s_nop 0
    v_mul_f32 v9, v16, v32
    v_mul_f32 v10, v16, v24
    v_fmac_f32 v9, v17, v33
    v_fmac_f32 v10, v17, v25
    v_fmac_f32 v9, v18, v34
    v_fmac_f32 v10, v18, v26
    v_fmac_f32 v9, v19, v35
    v_fmac_f32 v10, v19, v27
    v_fmac_f32 v9, v20, v36
    v_fmac_f32 v10, v20, v28
    v_fmac_f32 v9, v21, v37
    v_fmac_f32 v10, v21, v29
    v_fmac_f32 v9, v22, v38
    v_fmac_f32 v10, v22, v30
    v_fmac_f32 v9, v23, v39
    v_fmac_f32 v10, v23, v31
    v_lshlrev_b32 v44, 9, v41
    v_lshl_add_u32 v44, v40, 2, v44
    ds_write_b32 v44, v9 offset:43776
    v_lshlrev_b32 v44, 2, v41
    ds_write_b32 v44, v10 offset:47872
    s_waitcnt lgkmcnt(0)
    s_barrier
    s_cmp_ge_u32 s14, 8
    s_cbranch_scc1 L_DONE
    v_and_b32 v45, 255, v0
    s_cmp_ge_u32 s14, 2
    s_cbranch_scc1 L_APUB_SKIP
    v_lshlrev_b32 v44, 2, v0
    ds_read_b32 v32, v44 offset:43776
    ds_read_b32 v33, v44 offset:44288
    ds_read_b32 v34, v44 offset:44800
    ds_read_b32 v35, v44 offset:45312
    ds_read_b32 v36, v44 offset:45824
    ds_read_b32 v37, v44 offset:46336
    ds_read_b32 v38, v44 offset:46848
    ds_read_b32 v39, v44 offset:47360
    v_mov_b32 v3, 0
    ds_read_b128 v[24:27], v3 offset:47872
    ds_read_b128 v[28:31], v3 offset:47888
    s_waitcnt lgkmcnt(0)
    v_add_f32 v32, v32, v33
    v_add_f32 v24, v24, v25
    v_add_f32 v32, v32, v34
    v_add_f32 v24, v24, v26
    v_add_f32 v32, v32, v35
    v_add_f32 v24, v24, v27
    v_add_f32 v32, v32, v36
    v_add_f32 v24, v24, v28
    v_add_f32 v32, v32, v37
    v_add_f32 v24, v24, v29
    v_add_f32 v32, v32, v38
    v_add_f32 v24, v24, v30
    v_add_f32 v32, v32, v39
    v_add_f32 v24, v24, v31
    s_lshl_b32 s93, s3, 9
    buffer_store_dword v32, v44, s[36:39], s93 offen offset:0 sc1
    v_mov_b32 v43, v24
    s_cmp_lg_u32 s14, 0
    s_cbranch_scc1 L_APUB_SKIP
    s_lshl_b32 s93, s3, 3
    s_add_u32 s93, s93, 262144
    s_mov_b64 exec, 1
    buffer_store_dwordx2 v[42:43], v3, s[36:39], s93 offen sc1
    s_mov_b64 exec, -1
L_APUB_SKIP:
    s_cmp_lg_u32 s14, 4
    s_cbranch_scc1 L_P1_SKIP
    v_mov_b32 v3, 128
    s_mov_b32 s92, 0
L_PCLEAN:
    buffer_load_dword v44, v3, s[40:43], 0 offen sc1
    s_waitcnt vmcnt(0)
    v_readfirstlane_b32 s93, v44
    s_cmp_ge_u32 s93, 256
    s_cbranch_scc1 L_PCLEAN_D
    s_sleep 4
    s_add_u32 s92, s92, 1
    s_cmp_lt_u32 s92, 262144
    s_cbranch_scc1 L_PCLEAN
L_PCLEAN_D:
    s_mov_b64 exec, 0xffff
    v_lshrrev_b32 v3, 3, v1
    v_and_b32 v40, 7, v1
    v_lshlrev_b32 v3, 10, v3
    v_lshl_add_u32 v3, v40, 3, v3
    s_lshl_b32 s93, s91, 6
    s_add_u32 s93, s93, 262144
    s_mov_b32 s92, 0
L_PML:
    buffer_load_dwordx2 v[44:45], v3, s[36:39], s93 offen sc1
    s_waitcnt vmcnt(0)
    v_cmp_u_f32 vcc, v44, v45
    s_cbranch_vccz L_PML_D
    s_sleep 4
    s_add_u32 s92, s92, 1
    s_cmp_lt_u32 s92, 262144
    s_cbranch_scc1 L_PML
L_PML_D:
    s_mov_b64 exec, -1
    v_and_b32 v45, 255, v0
L_P1_SKIP:
    s_barrier
    s_cmp_lt_u32 s14, 4
    s_cbranch_scc1 L_B1_SKIP
    v_lshrrev_b32 v41, 7, v45
    v_and_b32 v40, 127, v45
    v_lshlrev_b32 v44, 11, v41
    v_lshl_add_u32 v44, v40, 2, v44
    v_lshlrev_b32 v3, 5, v41
    s_mov_b32 s99, 0
L_B1_RETRY:
    s_lshl_b32 s93, s91, 12
    s_add_u32 s93, s93, 0
    buffer_load_dword v16, v44, s[36:39], s93 offen offset:0 sc1
    buffer_load_dword v17, v44, s[36:39], s93 offen offset:512 sc1
    buffer_load_dword v18, v44, s[36:39], s93 offen offset:1024 sc1
    buffer_load_dword v19, v44, s[36:39], s93 offen offset:1536 sc1
    s_lshl_b32 s92, s91, 6
    s_add_u32 s92, s92, 262144
    buffer_load_dwordx4 v[64:67], v3, s[36:39], s92 offen sc1
    buffer_load_dwordx4 v[68:71], v3, s[36:39], s92 offen offset:16 sc1
    s_lshl_b32 s93, s91, 12
    s_add_u32 s93, s93, 65536
    buffer_load_dword v20, v44, s[36:39], s93 offen offset:0 sc1
    buffer_load_dword v21, v44, s[36:39], s93 offen offset:512 sc1
    buffer_load_dword v22, v44, s[36:39], s93 offen offset:1024 sc1
    buffer_load_dword v23, v44, s[36:39], s93 offen offset:1536 sc1
    s_lshl_b32 s92, s91, 6
    s_add_u32 s92, s92, 263168
    buffer_load_dwordx4 v[72:75], v3, s[36:39], s92 offen sc1
    buffer_load_dwordx4 v[76:79], v3, s[36:39], s92 offen offset:16 sc1
    s_waitcnt vmcnt(0)
    v_max3_f32 v32, v64, v66, v68
    v_max_f32 v32, v32, v70
    v_mul_f32 v33, s98, v32
    v_fma_f32 v64, v64, s98, -v33
    v_fma_f32 v66, v66, s98, -v33
    v_fma_f32 v68, v68, s98, -v33
    v_fma_f32 v70, v70, s98, -v33
    v_exp_f32 v64, v64
    v_exp_f32 v66, v66
    v_exp_f32 v68, v68
    v_exp_f32 v70, v70
    s_nop 0
    v_mul_f32 v34, v64, v65
    v_mul_f32 v35, v64, v16
    v_fmac_f32 v34, v66, v67
    v_fmac_f32 v35, v66, v17
    v_fmac_f32 v34, v68, v69
    v_fmac_f32 v35, v68, v18
    v_fmac_f32 v34, v70, v71
    v_fmac_f32 v35, v70, v19
    v_rcp_f32 v36, v34
    s_nop 0
    v_mul_f32 v37, v35, v36
    v_fma_f32 v38, -v37, v34, v35
    v_fma_f32 v46, v38, v36, v37
    v_max3_f32 v32, v72, v74, v76
    v_max_f32 v32, v32, v78
    v_mul_f32 v33, s98, v32
    v_fma_f32 v72, v72, s98, -v33
    v_fma_f32 v74, v74, s98, -v33
    v_fma_f32 v76, v76, s98, -v33
    v_fma_f32 v78, v78, s98, -v33
    v_exp_f32 v72, v72
    v_exp_f32 v74, v74
    v_exp_f32 v76, v76
    v_exp_f32 v78, v78
    s_nop 0
    v_mul_f32 v34, v72, v73
    v_mul_f32 v35, v72, v20
    v_fmac_f32 v34, v74, v75
    v_fmac_f32 v35, v74, v21
    v_fmac_f32 v34, v76, v77
    v_fmac_f32 v35, v76, v22
    v_fmac_f32 v34, v78, v79
    v_fmac_f32 v35, v78, v23
    v_rcp_f32 v36, v34
    s_nop 0
    v_mul_f32 v37, v35, v36
    v_fma_f32 v38, -v37, v34, v35
    v_fma_f32 v47, v38, v36, v37
    v_cmp_u_f32 vcc, v46, v47
    s_cbranch_vccz L_B1_OK
    s_add_u32 s99, s99, 1
    s_cmp_lt_u32 s99, 262144
    s_cbranch_scc1 L_B1_RETRY
L_B1_OK:
    v_lshlrev_b32 v44, 2, v45
    v_cvt_pk_bf16_f32 v38, v46, v46
    v_lshlrev_b32 v46, 16, v38
    ds_write_b32 v44, v46 offset:47936
    v_cvt_pk_bf16_f32 v38, v47, v47
    v_lshlrev_b32 v47, 16, v38
    ds_write_b32 v44, v47 offset:48960
    s_waitcnt lgkmcnt(0)
L_B1_SKIP:
    s_barrier
    s_cmp_ge_u32 s14, 4
    s_cbranch_scc1 L_B2_SKIP
    v_and_b32 v44, 0xfc, v0
    ds_read_b32 v48, v44 offset:47936
    ds_read_b32 v49, v44 offset:48192
    ds_read_b32 v50, v44 offset:48448
    ds_read_b32 v51, v44 offset:48704
    ds_read_b32 v52, v44 offset:48960
    ds_read_b32 v53, v44 offset:49216
    ds_read_b32 v54, v44 offset:49472
    ds_read_b32 v55, v44 offset:49728
    s_waitcnt vmcnt(0) lgkmcnt(0)
    v_lshlrev_b32 v32, 16, v64
    v_and_b32 v33, 0xffff0000, v64
    v_lshlrev_b32 v34, 16, v65
    v_and_b32 v35, 0xffff0000, v65
    v_lshlrev_b32 v36, 16, v66
    v_and_b32 v37, 0xffff0000, v66
    v_lshlrev_b32 v38, 16, v67
    v_and_b32 v39, 0xffff0000, v67
    v_pk_mul_f32 v[16:17], v[32:33], v[48:49] op_sel_hi:[1,0]
    v_pk_mul_f32 v[18:19], v[34:35], v[48:49] op_sel_hi:[1,0]
    v_pk_mul_f32 v[20:21], v[36:37], v[48:49] op_sel_hi:[1,0]
    v_pk_mul_f32 v[22:23], v[38:39], v[48:49] op_sel_hi:[1,0]
    v_pk_mul_f32 v[24:25], v[32:33], v[52:53] op_sel_hi:[1,0]
    v_pk_mul_f32 v[26:27], v[34:35], v[52:53] op_sel_hi:[1,0]
    v_pk_mul_f32 v[28:29], v[36:37], v[52:53] op_sel_hi:[1,0]
    v_pk_mul_f32 v[30:31], v[38:39], v[52:53] op_sel_hi:[1,0]
    v_lshlrev_b32 v32, 16, v68
    v_and_b32 v33, 0xffff0000, v68
    v_lshlrev_b32 v34, 16, v69
    v_and_b32 v35, 0xffff0000, v69
    v_lshlrev_b32 v36, 16, v70
    v_and_b32 v37, 0xffff0000, v70
    v_lshlrev_b32 v38, 16, v71
    v_and_b32 v39, 0xffff0000, v71
    v_pk_fma_f32 v[16:17], v[32:33], v[48:49], v[16:17] op_sel:[0,1,0] op_sel_hi:[1,1,1]
    v_pk_fma_f32 v[18:19], v[34:35], v[48:49], v[18:19] op_sel:[0,1,0] op_sel_hi:[1,1,1]
    v_pk_fma_f32 v[20:21], v[36:37], v[48:49], v[20:21] op_sel:[0,1,0] op_sel_hi:[1,1,1]
    v_pk_fma_f32 v[22:23], v[38:39], v[48:49], v[22:23] op_sel:[0,1,0] op_sel_hi:[1,1,1]
    v_pk_fma_f32 v[24:25], v[32:33], v[52:53], v[24:25] op_sel:[0,1,0] op_sel_hi:[1,1,1]
    v_pk_fma_f32 v[26:27], v[34:35], v[52:53], v[26:27] op_sel:[0,1,0] op_sel_hi:[1,1,1]
    v_pk_fma_f32 v[28:29], v[36:37], v[52:53], v[28:29] op_sel:[0,1,0] op_sel_hi:[1,1,1]
    v_pk_fma_f32 v[30:31], v[38:39], v[52:53], v[30:31] op_sel:[0,1,0] op_sel_hi:[1,1,1]
    v_lshlrev_b32 v32, 16, v72
    v_and_b32 v33, 0xffff0000, v72
    v_lshlrev_b32 v34, 16, v73
    v_and_b32 v35, 0xffff0000, v73
    v_lshlrev_b32 v36, 16, v74
    v_and_b32 v37, 0xffff0000, v74
    v_lshlrev_b32 v38, 16, v75
    v_and_b32 v39, 0xffff0000, v75
    v_pk_fma_f32 v[16:17], v[32:33], v[50:51], v[16:17] op_sel_hi:[1,0,1]
    v_pk_fma_f32 v[18:19], v[34:35], v[50:51], v[18:19] op_sel_hi:[1,0,1]
    v_pk_fma_f32 v[20:21], v[36:37], v[50:51], v[20:21] op_sel_hi:[1,0,1]
    v_pk_fma_f32 v[22:23], v[38:39], v[50:51], v[22:23] op_sel_hi:[1,0,1]
    v_pk_fma_f32 v[24:25], v[32:33], v[54:55], v[24:25] op_sel_hi:[1,0,1]
    v_pk_fma_f32 v[26:27], v[34:35], v[54:55], v[26:27] op_sel_hi:[1,0,1]
    v_pk_fma_f32 v[28:29], v[36:37], v[54:55], v[28:29] op_sel_hi:[1,0,1]
    v_pk_fma_f32 v[30:31], v[38:39], v[54:55], v[30:31] op_sel_hi:[1,0,1]
    v_lshlrev_b32 v32, 16, v76
    v_and_b32 v33, 0xffff0000, v76
    v_lshlrev_b32 v34, 16, v77
    v_and_b32 v35, 0xffff0000, v77
    v_lshlrev_b32 v36, 16, v78
    v_and_b32 v37, 0xffff0000, v78
    v_lshlrev_b32 v38, 16, v79
    v_and_b32 v39, 0xffff0000, v79
    v_pk_fma_f32 v[16:17], v[32:33], v[50:51], v[16:17] op_sel:[0,1,0] op_sel_hi:[1,1,1]
    v_pk_fma_f32 v[18:19], v[34:35], v[50:51], v[18:19] op_sel:[0,1,0] op_sel_hi:[1,1,1]
    v_pk_fma_f32 v[20:21], v[36:37], v[50:51], v[20:21] op_sel:[0,1,0] op_sel_hi:[1,1,1]
    v_pk_fma_f32 v[22:23], v[38:39], v[50:51], v[22:23] op_sel:[0,1,0] op_sel_hi:[1,1,1]
    v_pk_fma_f32 v[24:25], v[32:33], v[54:55], v[24:25] op_sel:[0,1,0] op_sel_hi:[1,1,1]
    v_pk_fma_f32 v[26:27], v[34:35], v[54:55], v[26:27] op_sel:[0,1,0] op_sel_hi:[1,1,1]
    v_pk_fma_f32 v[28:29], v[36:37], v[54:55], v[28:29] op_sel:[0,1,0] op_sel_hi:[1,1,1]
    v_pk_fma_f32 v[30:31], v[38:39], v[54:55], v[30:31] op_sel:[0,1,0] op_sel_hi:[1,1,1]
    s_nop 1
    v_permlane32_swap_b32 v16, v24
    v_permlane32_swap_b32 v17, v25
    v_permlane32_swap_b32 v18, v26
    v_permlane32_swap_b32 v19, v27
    v_permlane32_swap_b32 v20, v28
    v_permlane32_swap_b32 v21, v29
    v_permlane32_swap_b32 v22, v30
    v_permlane32_swap_b32 v23, v31
    s_nop 1
    v_add_f32 v16, v16, v24
    v_add_f32 v17, v17, v25
    v_add_f32 v18, v18, v26
    v_add_f32 v19, v19, v27
    v_add_f32 v20, v20, v28
    v_add_f32 v21, v21, v29
    v_add_f32 v22, v22, v30
    v_add_f32 v23, v23, v31
    s_nop 1
    v_permlane16_swap_b32 v16, v20
    v_permlane16_swap_b32 v17, v21
    v_permlane16_swap_b32 v18, v22
    v_permlane16_swap_b32 v19, v23
    s_nop 1
    v_add_f32 v16, v16, v20
    v_add_f32 v17, v17, v21
    v_add_f32 v18, v18, v22
    v_add_f32 v19, v19, v23
    s_nop 1
    v_add_f32_dpp v16, v16, v16 row_ror:8 row_mask:0xf bank_mask:0xf
    v_add_f32_dpp v17, v17, v17 row_ror:8 row_mask:0xf bank_mask:0xf
    v_add_f32_dpp v18, v18, v18 row_ror:8 row_mask:0xf bank_mask:0xf
    v_add_f32_dpp v19, v19, v19 row_ror:8 row_mask:0xf bank_mask:0xf
    v_add_f32_dpp v16, v16, v16 row_ror:4 row_mask:0xf bank_mask:0xf
    v_add_f32_dpp v17, v17, v17 row_ror:4 row_mask:0xf bank_mask:0xf
    v_add_f32_dpp v18, v18, v18 row_ror:4 row_mask:0xf bank_mask:0xf
    v_add_f32_dpp v19, v19, v19 row_ror:4 row_mask:0xf bank_mask:0xf
    s_nop 1
    v_lshlrev_b32 v44, 8, v2
    v_and_b32 v40, 3, v0
    v_lshl_add_u32 v44, v40, 5, v44
    v_and_b32 v40, 32, v0
    v_lshl_add_u32 v44, v40, 2, v44
    v_and_b32 v40, 16, v0
    v_add_u32 v44, v44, v40
    ds_write_b128 v44, v[16:19] offset:49984
    s_waitcnt lgkmcnt(0)
L_B2_SKIP:
    s_barrier
    s_cmp_lg_u32 s14, 0
    s_cbranch_scc1 L_B3_SKIP
    v_lshlrev_b32 v44, 2, v0
    ds_read_b32 v32, v44 offset:49984
    ds_read_b32 v33, v44 offset:50240
    ds_read_b32 v34, v44 offset:50496
    ds_read_b32 v35, v44 offset:50752
    s_waitcnt lgkmcnt(0)
    v_add_f32 v32, v32, v33
    v_add_f32 v34, v34, v35
    v_add_f32 v32, v32, v34
    v_lshrrev_b32 v44, 5, v0
    v_and_b32 v40, 31, v0
    v_lshlrev_b32 v44, 11, v44
    v_lshl_add_u32 v44, v40, 2, v44
    s_lshl_b32 s93, s91, 12
    s_lshl_b32 s92, s90, 7
    s_add_u32 s93, s93, s92
    s_add_u32 s93, s93, 524288
    buffer_store_dword v32, v44, s[36:39], s93 offen sc1
L_B3_SKIP:
    s_cmp_ge_u32 s11, 28
    s_cbranch_scc1 L_DONE
    s_cmp_lg_u32 s14, 4
    s_cbranch_scc1 L_P2_SKIP
    v_lshlrev_b32 v3, 5, v1
    s_mov_b32 s93, 262144
    s_mov_b32 s92, 0
L_PMLA:
    buffer_load_dwordx4 v[64:67], v3, s[36:39], s93 offen sc1
    buffer_load_dwordx4 v[68:71], v3, s[36:39], s93 offen offset:16 sc1
    s_waitcnt vmcnt(0)
    v_add_f32 v64, v64, v65
    v_add_f32 v64, v64, v66
    v_add_f32 v64, v64, v67
    v_add_f32 v64, v64, v68
    v_add_f32 v64, v64, v69
    v_add_f32 v64, v64, v70
    v_cmp_u_f32 vcc, v64, v71
    s_cbranch_vccz L_PMLA_D
    s_sleep 4
    s_add_u32 s92, s92, 1
    s_cmp_lt_u32 s92, 262144
    s_cbranch_scc1 L_PMLA
L_PMLA_D:
L_P2_SKIP:
    s_barrier
    s_cmp_lt_u32 s14, 4
    s_cbranch_scc1 L_C1_SKIP
    s_mov_b32 s28, s64
    s_and_b32 s29, s65, 0xffff
    s_mov_b32 s30, 2048
    s_mov_b32 s31, 0x00020000
    v_lshlrev_b32 v44, 4, v45
    v_lshlrev_b32 v3, 3, v45
    buffer_load_dwordx2 v[32:33], v3, s[28:31], 0 offen
    s_mov_b32 s99, 0
L_C1_RETRY:
    s_mov_b32 s93, 524288
    buffer_load_dwordx4 v[64:67], v44, s[36:39], s93 offen sc1
    s_mov_b32 s93, 528384
    buffer_load_dwordx4 v[68:71], v44, s[36:39], s93 offen sc1
    s_mov_b32 s93, 532480
    buffer_load_dwordx4 v[72:75], v44, s[36:39], s93 offen sc1
    s_mov_b32 s93, 536576
    buffer_load_dwordx4 v[76:79], v44, s[36:39], s93 offen sc1
    s_mov_b32 s93, 540672
    buffer_load_dwordx4 v[80:83], v44, s[36:39], s93 offen sc1
    s_mov_b32 s93, 544768
    buffer_load_dwordx4 v[84:87], v44, s[36:39], s93 offen sc1
    s_mov_b32 s93, 548864
    buffer_load_dwordx4 v[88:91], v44, s[36:39], s93 offen sc1
    s_mov_b32 s93, 552960
    buffer_load_dwordx4 v[92:95], v44, s[36:39], s93 offen sc1
    s_mov_b32 s93, 557056
    buffer_load_dwordx4 v[96:99], v44, s[36:39], s93 offen sc1
    s_mov_b32 s93, 561152
    buffer_load_dwordx4 v[100:103], v44, s[36:39], s93 offen sc1
    s_mov_b32 s93, 565248
    buffer_load_dwordx4 v[104:107], v44, s[36:39], s93 offen sc1
    s_mov_b32 s93, 569344
    buffer_load_dwordx4 v[108:111], v44, s[36:39], s93 offen sc1
    s_mov_b32 s93, 573440
    buffer_load_dwordx4 v[112:115], v44, s[36:39], s93 offen sc1
    s_mov_b32 s93, 577536
    buffer_load_dwordx4 v[116:119], v44, s[36:39], s93 offen sc1
    s_mov_b32 s93, 581632
    buffer_load_dwordx4 v[120:123], v44, s[36:39], s93 offen sc1
    s_mov_b32 s93, 585728
    buffer_load_dwordx4 v[124:127], v44, s[36:39], s93 offen sc1
    s_waitcnt vmcnt(0)
    v_add_f32 v64, v64, v68
    v_add_f32 v65, v65, v69
    v_add_f32 v66, v66, v70
    v_add_f32 v67, v67, v71
    v_add_f32 v64, v64, v72
    v_add_f32 v65, v65, v73
    v_add_f32 v66, v66, v74
    v_add_f32 v67, v67, v75
    v_add_f32 v64, v64, v76
    v_add_f32 v65, v65, v77
    v_add_f32 v66, v66, v78
    v_add_f32 v67, v67, v79
    v_add_f32 v64, v64, v80
    v_add_f32 v65, v65, v81
    v_add_f32 v66, v66, v82
    v_add_f32 v67, v67, v83
    v_add_f32 v64, v64, v84
    v_add_f32 v65, v65, v85
    v_add_f32 v66, v66, v86
    v_add_f32 v67, v67, v87
    v_add_f32 v64, v64, v88
    v_add_f32 v65, v65, v89
    v_add_f32 v66, v66, v90
    v_add_f32 v67, v67, v91
    v_add_f32 v64, v64, v92
    v_add_f32 v65, v65, v93
    v_add_f32 v66, v66, v94
    v_add_f32 v67, v67, v95
    v_add_f32 v64, v64, v96
    v_add_f32 v65, v65, v97
    v_add_f32 v66, v66, v98
    v_add_f32 v67, v67, v99
    v_add_f32 v64, v64, v100
    v_add_f32 v65, v65, v101
    v_add_f32 v66, v66, v102
    v_add_f32 v67, v67, v103
    v_add_f32 v64, v64, v104
    v_add_f32 v65, v65, v105
    v_add_f32 v66, v66, v106
    v_add_f32 v67, v67, v107
    v_add_f32 v64, v64, v108
    v_add_f32 v65, v65, v109
    v_add_f32 v66, v66, v110
    v_add_f32 v67, v67, v111
    v_add_f32 v64, v64, v112
    v_add_f32 v65, v65, v113
    v_add_f32 v66, v66, v114
    v_add_f32 v67, v67, v115
    v_add_f32 v64, v64, v116
    v_add_f32 v65, v65, v117
    v_add_f32 v66, v66, v118
    v_add_f32 v67, v67, v119
    v_add_f32 v64, v64, v120
    v_add_f32 v65, v65, v121
    v_add_f32 v66, v66, v122
    v_add_f32 v67, v67, v123
    v_add_f32 v64, v64, v124
    v_add_f32 v65, v65, v125
    v_add_f32 v66, v66, v126
    v_add_f32 v67, v67, v127
    v_add_f32 v34, v64, v65
    v_add_f32 v35, v66, v67
    v_cmp_u_f32 vcc, v34, v35
    s_cbranch_vccz L_C1_OK
    s_add_u32 s99, s99, 1
    s_cmp_lt_u32 s99, 262144
    s_cbranch_scc1 L_C1_RETRY
L_C1_OK:
    v_lshlrev_b32 v16, 16, v32
    v_and_b32 v17, 0xffff0000, v32
    v_lshlrev_b32 v18, 16, v33
    v_and_b32 v19, 0xffff0000, v33
    v_cvt_pk_bf16_f32 v34, v64, v64
    v_lshlrev_b32 v64, 16, v34
    v_add_f32 v16, v16, v64
    v_cvt_pk_bf16_f32 v34, v16, v16
    v_lshlrev_b32 v16, 16, v34
    v_cvt_pk_bf16_f32 v34, v65, v65
    v_lshlrev_b32 v65, 16, v34
    v_add_f32 v17, v17, v65
    v_cvt_pk_bf16_f32 v34, v17, v17
    v_lshlrev_b32 v17, 16, v34
    v_cvt_pk_bf16_f32 v34, v66, v66
    v_lshlrev_b32 v66, 16, v34
    v_add_f32 v18, v18, v66
    v_cvt_pk_bf16_f32 v34, v18, v18
    v_lshlrev_b32 v18, 16, v34
    v_cvt_pk_bf16_f32 v34, v67, v67
    v_lshlrev_b32 v67, 16, v34
    v_add_f32 v19, v19, v67
    v_cvt_pk_bf16_f32 v34, v19, v19
    v_lshlrev_b32 v19, 16, v34
    ds_write_b128 v44, v[16:19] offset:58176
    v_add_f32 v35, v16, v17
    v_add_f32 v37, v18, v19
    v_add_f32 v35, v35, v37
    s_nop 1
    v_add_f32_dpp v35, v35, v35 row_ror:8 row_mask:0xf bank_mask:0xf
    s_nop 1
    v_add_f32_dpp v35, v35, v35 row_ror:4 row_mask:0xf bank_mask:0xf
    s_nop 1
    v_add_f32_dpp v35, v35, v35 row_ror:2 row_mask:0xf bank_mask:0xf
    s_nop 1
    v_add_f32_dpp v35, v35, v35 row_ror:1 row_mask:0xf bank_mask:0xf
    s_nop 1
    v_mov_b32 v37, v35
    s_nop 1
    v_permlane16_swap_b32 v35, v37
    s_nop 1
    v_add_f32 v35, v35, v37
    s_nop 1
    v_mov_b32 v37, v35
    s_nop 1
    v_permlane32_swap_b32 v35, v37
    s_nop 1
    v_add_f32 v35, v35, v37
    s_nop 1
    v_lshlrev_b32 v40, 2, v2
    ds_write_b32 v40, v35 offset:62272
    s_waitcnt lgkmcnt(0)
L_C1_SKIP:
    s_barrier
    s_cmp_lt_u32 s14, 4
    s_cbranch_scc1 L_C2_SKIP
    v_and_b32 v41, 6, v2
    v_lshlrev_b32 v41, 2, v41
    ds_read_b64 v[24:25], v41 offset:62272
    s_waitcnt lgkmcnt(0)
    v_add_f32 v35, v24, v25
    v_mul_f32 v35, 0x3b000000, v35
    v_sub_f32 v20, v16, v35
    v_sub_f32 v21, v17, v35
    v_sub_f32 v22, v18, v35
    v_sub_f32 v23, v19, v35
    v_mul_f32 v36, v20, v20
    v_fmac_f32 v36, v21, v21
    v_fmac_f32 v36, v22, v22
    v_fmac_f32 v36, v23, v23
    s_nop 1
    s_nop 1
    v_add_f32_dpp v36, v36, v36 row_ror:8 row_mask:0xf bank_mask:0xf
    s_nop 1
    v_add_f32_dpp v36, v36, v36 row_ror:4 row_mask:0xf bank_mask:0xf
    s_nop 1
    v_add_f32_dpp v36, v36, v36 row_ror:2 row_mask:0xf bank_mask:0xf
    s_nop 1
    v_add_f32_dpp v36, v36, v36 row_ror:1 row_mask:0xf bank_mask:0xf
    s_nop 1
    v_mov_b32 v37, v36
    s_nop 1
    v_permlane16_swap_b32 v36, v37
    s_nop 1
    v_add_f32 v36, v36, v37
    s_nop 1
    v_mov_b32 v37, v36
    s_nop 1
    v_permlane32_swap_b32 v36, v37
    s_nop 1
    v_add_f32 v36, v36, v37
    s_nop 1
    ds_write_b32 v40, v36 offset:62336
    s_waitcnt lgkmcnt(0)
L_C2_SKIP:
    s_barrier
    s_cmp_lt_u32 s14, 4
    s_cbranch_scc1 L_C3_SKIP
    ds_read_b64 v[24:25], v41 offset:62336
    s_waitcnt lgkmcnt(0)
    v_add_f32 v36, v24, v25
    v_mul_f32 v36, 0x3b000000, v36
    v_cvt_pk_bf16_f32 v37, v36, v36
    v_lshlrev_b32 v36, 16, v37
    v_cvt_pk_bf16_f32 v37, v35, v35
    v_lshlrev_b32 v35, 16, v37
    v_add_f32 v36, 0x3727c5ac, v36
    v_cvt_pk_bf16_f32 v37, v36, v36
    v_lshlrev_b32 v36, 16, v37
    v_sqrt_f32 v36, v36
    s_nop 0
    v_cvt_pk_bf16_f32 v37, v36, v36
    v_lshlrev_b32 v36, 16, v37
    v_rcp_f32 v38, v36
    s_nop 0
    v_sub_f32 v20, v16, v35
    v_cvt_pk_bf16_f32 v37, v20, v20
    v_lshlrev_b32 v20, 16, v37
    v_mul_f32 v26, v20, v38
    v_fma_f32 v27, -v26, v36, v20
    v_fma_f32 v20, v27, v38, v26
    v_cvt_pk_bf16_f32 v37, v20, v20
    v_lshlrev_b32 v20, 16, v37
    v_sub_f32 v21, v17, v35
    v_cvt_pk_bf16_f32 v37, v21, v21
    v_lshlrev_b32 v21, 16, v37
    v_mul_f32 v26, v21, v38
    v_fma_f32 v27, -v26, v36, v21
    v_fma_f32 v21, v27, v38, v26
    v_cvt_pk_bf16_f32 v37, v21, v21
    v_lshlrev_b32 v21, 16, v37
    v_sub_f32 v22, v18, v35
    v_cvt_pk_bf16_f32 v37, v22, v22
    v_lshlrev_b32 v22, 16, v37
    v_mul_f32 v26, v22, v38
    v_fma_f32 v27, -v26, v36, v22
    v_fma_f32 v22, v27, v38, v26
    v_cvt_pk_bf16_f32 v37, v22, v22
    v_lshlrev_b32 v22, 16, v37
    v_sub_f32 v23, v19, v35
    v_cvt_pk_bf16_f32 v37, v23, v23
    v_lshlrev_b32 v23, 16, v37
    v_mul_f32 v26, v23, v38
    v_fma_f32 v27, -v26, v36, v23
    v_fma_f32 v23, v27, v38, v26
    v_cvt_pk_bf16_f32 v37, v23, v23
    v_lshlrev_b32 v23, 16, v37
    ds_write_b128 v44, v[20:23] offset:54080
    s_waitcnt lgkmcnt(0)
L_C3_SKIP:
    s_barrier
    s_cmp_ge_u32 s14, 4
    s_cbranch_scc1 L_DONE
    v_lshrrev_b32 v44, 1, v0
    v_lshlrev_b32 v44, 2, v44
    ds_read_b32 v48, v44 offset:54080
    ds_read_b32 v49, v44 offset:54592
    ds_read_b32 v50, v44 offset:55104
    ds_read_b32 v51, v44 offset:55616
    ds_read_b32 v52, v44 offset:56128
    ds_read_b32 v53, v44 offset:56640
    ds_read_b32 v54, v44 offset:57152
    ds_read_b32 v55, v44 offset:57664
    s_waitcnt lgkmcnt(0)
    v_lshlrev_b32 v32, 16, v80
    v_and_b32 v33, 0xffff0000, v80
    v_lshlrev_b32 v34, 16, v81
    v_and_b32 v35, 0xffff0000, v81
    v_lshlrev_b32 v36, 16, v82
    v_and_b32 v37, 0xffff0000, v82
    v_lshlrev_b32 v38, 16, v83
    v_and_b32 v39, 0xffff0000, v83
    v_pk_mul_f32 v[16:17], v[32:33], v[48:49] op_sel_hi:[1,0]
    v_pk_mul_f32 v[18:19], v[34:35], v[48:49] op_sel_hi:[1,0]
    v_pk_mul_f32 v[20:21], v[36:37], v[48:49] op_sel_hi:[1,0]
    v_pk_mul_f32 v[22:23], v[38:39], v[48:49] op_sel_hi:[1,0]
    v_pk_mul_f32 v[24:25], v[32:33], v[52:53] op_sel_hi:[1,0]
    v_pk_mul_f32 v[26:27], v[34:35], v[52:53] op_sel_hi:[1,0]
    v_pk_mul_f32 v[28:29], v[36:37], v[52:53] op_sel_hi:[1,0]
    v_pk_mul_f32 v[30:31], v[38:39], v[52:53] op_sel_hi:[1,0]
    v_lshlrev_b32 v32, 16, v84
    v_and_b32 v33, 0xffff0000, v84
    v_lshlrev_b32 v34, 16, v85
    v_and_b32 v35, 0xffff0000, v85
    v_lshlrev_b32 v36, 16, v86
    v_and_b32 v37, 0xffff0000, v86
    v_lshlrev_b32 v38, 16, v87
    v_and_b32 v39, 0xffff0000, v87
    v_pk_fma_f32 v[16:17], v[32:33], v[48:49], v[16:17] op_sel:[0,1,0] op_sel_hi:[1,1,1]
    v_pk_fma_f32 v[18:19], v[34:35], v[48:49], v[18:19] op_sel:[0,1,0] op_sel_hi:[1,1,1]
    v_pk_fma_f32 v[20:21], v[36:37], v[48:49], v[20:21] op_sel:[0,1,0] op_sel_hi:[1,1,1]
    v_pk_fma_f32 v[22:23], v[38:39], v[48:49], v[22:23] op_sel:[0,1,0] op_sel_hi:[1,1,1]
    v_pk_fma_f32 v[24:25], v[32:33], v[52:53], v[24:25] op_sel:[0,1,0] op_sel_hi:[1,1,1]
    v_pk_fma_f32 v[26:27], v[34:35], v[52:53], v[26:27] op_sel:[0,1,0] op_sel_hi:[1,1,1]
    v_pk_fma_f32 v[28:29], v[36:37], v[52:53], v[28:29] op_sel:[0,1,0] op_sel_hi:[1,1,1]
    v_pk_fma_f32 v[30:31], v[38:39], v[52:53], v[30:31] op_sel:[0,1,0] op_sel_hi:[1,1,1]
    v_lshlrev_b32 v32, 16, v88
    v_and_b32 v33, 0xffff0000, v88
    v_lshlrev_b32 v34, 16, v89
    v_and_b32 v35, 0xffff0000, v89
    v_lshlrev_b32 v36, 16, v90
    v_and_b32 v37, 0xffff0000, v90
    v_lshlrev_b32 v38, 16, v91
    v_and_b32 v39, 0xffff0000, v91
    v_pk_fma_f32 v[16:17], v[32:33], v[50:51], v[16:17] op_sel_hi:[1,0,1]
    v_pk_fma_f32 v[18:19], v[34:35], v[50:51], v[18:19] op_sel_hi:[1,0,1]
    v_pk_fma_f32 v[20:21], v[36:37], v[50:51], v[20:21] op_sel_hi:[1,0,1]
    v_pk_fma_f32 v[22:23], v[38:39], v[50:51], v[22:23] op_sel_hi:[1,0,1]
    v_pk_fma_f32 v[24:25], v[32:33], v[54:55], v[24:25] op_sel_hi:[1,0,1]
    v_pk_fma_f32 v[26:27], v[34:35], v[54:55], v[26:27] op_sel_hi:[1,0,1]
    v_pk_fma_f32 v[28:29], v[36:37], v[54:55], v[28:29] op_sel_hi:[1,0,1]
    v_pk_fma_f32 v[30:31], v[38:39], v[54:55], v[30:31] op_sel_hi:[1,0,1]
    v_lshlrev_b32 v32, 16, v92
    v_and_b32 v33, 0xffff0000, v92
    v_lshlrev_b32 v34, 16, v93
    v_and_b32 v35, 0xffff0000, v93
    v_lshlrev_b32 v36, 16, v94
    v_and_b32 v37, 0xffff0000, v94
    v_lshlrev_b32 v38, 16, v95
    v_and_b32 v39, 0xffff0000, v95
    v_pk_fma_f32 v[16:17], v[32:33], v[50:51], v[16:17] op_sel:[0,1,0] op_sel_hi:[1,1,1]
    v_pk_fma_f32 v[18:19], v[34:35], v[50:51], v[18:19] op_sel:[0,1,0] op_sel_hi:[1,1,1]
    v_pk_fma_f32 v[20:21], v[36:37], v[50:51], v[20:21] op_sel:[0,1,0] op_sel_hi:[1,1,1]
    v_pk_fma_f32 v[22:23], v[38:39], v[50:51], v[22:23] op_sel:[0,1,0] op_sel_hi:[1,1,1]
    v_pk_fma_f32 v[24:25], v[32:33], v[54:55], v[24:25] op_sel:[0,1,0] op_sel_hi:[1,1,1]
    v_pk_fma_f32 v[26:27], v[34:35], v[54:55], v[26:27] op_sel:[0,1,0] op_sel_hi:[1,1,1]
    v_pk_fma_f32 v[28:29], v[36:37], v[54:55], v[28:29] op_sel:[0,1,0] op_sel_hi:[1,1,1]
    v_pk_fma_f32 v[30:31], v[38:39], v[54:55], v[30:31] op_sel:[0,1,0] op_sel_hi:[1,1,1]
    s_nop 1
    v_permlane32_swap_b32 v16, v24
    v_permlane32_swap_b32 v17, v25
    v_permlane32_swap_b32 v18, v26
    v_permlane32_swap_b32 v19, v27
    v_permlane32_swap_b32 v20, v28
    v_permlane32_swap_b32 v21, v29
    v_permlane32_swap_b32 v22, v30
    v_permlane32_swap_b32 v23, v31
    s_nop 1
    v_add_f32 v16, v16, v24
    v_add_f32 v17, v17, v25
    v_add_f32 v18, v18, v26
    v_add_f32 v19, v19, v27
    v_add_f32 v20, v20, v28
    v_add_f32 v21, v21, v29
    v_add_f32 v22, v22, v30
    v_add_f32 v23, v23, v31
    s_nop 1
    v_permlane16_swap_b32 v16, v20
    v_permlane16_swap_b32 v17, v21
    v_permlane16_swap_b32 v18, v22
    v_permlane16_swap_b32 v19, v23
    s_nop 1
    v_add_f32 v16, v16, v20
    v_add_f32 v17, v17, v21
    v_add_f32 v18, v18, v22
    v_add_f32 v19, v19, v23
    s_nop 1
    v_add_f32_dpp v16, v16, v16 row_ror:8 row_mask:0xf bank_mask:0xf
    v_add_f32_dpp v17, v17, v17 row_ror:8 row_mask:0xf bank_mask:0xf
    v_add_f32_dpp v18, v18, v18 row_ror:8 row_mask:0xf bank_mask:0xf
    v_add_f32_dpp v19, v19, v19 row_ror:8 row_mask:0xf bank_mask:0xf
    v_add_f32_dpp v16, v16, v16 row_ror:4 row_mask:0xf bank_mask:0xf
    v_add_f32_dpp v17, v17, v17 row_ror:4 row_mask:0xf bank_mask:0xf
    v_add_f32_dpp v18, v18, v18 row_ror:4 row_mask:0xf bank_mask:0xf
    v_add_f32_dpp v19, v19, v19 row_ror:4 row_mask:0xf bank_mask:0xf
    v_add_f32_dpp v16, v16, v16 row_ror:2 row_mask:0xf bank_mask:0xf
    v_add_f32_dpp v17, v17, v17 row_ror:2 row_mask:0xf bank_mask:0xf
    v_add_f32_dpp v18, v18, v18 row_ror:2 row_mask:0xf bank_mask:0xf
    v_add_f32_dpp v19, v19, v19 row_ror:2 row_mask:0xf bank_mask:0xf
    s_nop 1
    v_lshlrev_b32 v44, 7, v2
    v_and_b32 v40, 1, v0
    v_lshl_add_u32 v44, v40, 6, v44
    v_and_b32 v40, 48, v0
    v_add_u32 v44, v44, v40
    ds_write_b128 v44, v[16:19] offset:62400
    s_waitcnt lgkmcnt(0)
    s_barrier
    s_cmp_lg_u32 s14, 0
    s_cbranch_scc1 L_C4_SKIP
    s_mov_b64 exec, 0xffff
    v_lshlrev_b32 v44, 2, v0
    ds_read_b32 v16, v44 offset:62400
    ds_read_b32 v20, v44 offset:62464
    ds_read_b32 v17, v44 offset:62528
    ds_read_b32 v21, v44 offset:62592
    ds_read_b32 v18, v44 offset:62656
    ds_read_b32 v22, v44 offset:62720
    ds_read_b32 v19, v44 offset:62784
    ds_read_b32 v23, v44 offset:62848
    s_waitcnt lgkmcnt(0)
    v_add_f32 v16, v16, v17
    v_add_f32 v20, v20, v21
    v_add_f32 v16, v16, v18
    v_add_f32 v20, v20, v22
    v_add_f32 v16, v16, v19
    v_add_f32 v20, v20, v23
    v_cvt_pk_bf16_f32 v32, v16, v16
    v_lshlrev_b32 v16, 16, v32
    v_cvt_pk_bf16_f32 v32, v20, v20
    v_lshlrev_b32 v20, 16, v32
    v_mul_f32 v33, s98, v16
    v_exp_f32 v33, -v33
    s_nop 0
    v_add_f32 v33, 1.0, v33
    v_rcp_f32 v34, v33
    s_nop 0
    v_mul_f32 v35, v16, v34
    v_fma_f32 v36, -v35, v33, v16
    v_fma_f32 v35, v36, v34, v35
    v_cvt_pk_bf16_f32 v32, v35, v35
    v_lshlrev_b32 v35, 16, v32
    v_mul_f32 v35, v35, v20
    v_cvt_pk_bf16_f32 v32, v35, v35
    v_lshlrev_b32 v35, 16, v32
    v_lshrrev_b32 v44, 3, v0
    v_and_b32 v40, 7, v0
    v_lshlrev_b32 v44, 13, v44
    v_lshl_add_u32 v44, v40, 2, v44
    s_lshl_b32 s93, s12, 5
    s_add_u32 s93, s93, 786432
    buffer_store_dword v35, v44, s[36:39], s93 offen sc1
    s_mov_b64 exec, -1
L_C4_SKIP:
    s_cmp_ge_u32 s11, 8
    s_cbranch_scc1 L_DONE
    v_lshlrev_b32 v44, 2, v0
    s_mov_b32 s99, 0
L_D_RETRY:
    s_mov_b32 s93, 786432
    buffer_load_dword v48, v44, s[36:39], s93 offen sc1
    s_mov_b32 s93, 787456
    buffer_load_dword v49, v44, s[36:39], s93 offen sc1
    s_mov_b32 s93, 788480
    buffer_load_dword v50, v44, s[36:39], s93 offen sc1
    s_mov_b32 s93, 789504
    buffer_load_dword v51, v44, s[36:39], s93 offen sc1
    s_mov_b32 s93, 790528
    buffer_load_dword v52, v44, s[36:39], s93 offen sc1
    s_mov_b32 s93, 791552
    buffer_load_dword v53, v44, s[36:39], s93 offen sc1
    s_mov_b32 s93, 792576
    buffer_load_dword v54, v44, s[36:39], s93 offen sc1
    s_mov_b32 s93, 794624
    buffer_load_dword v55, v44, s[36:39], s93 offen sc1
    s_mov_b32 s93, 795648
    buffer_load_dword v56, v44, s[36:39], s93 offen sc1
    s_mov_b32 s93, 796672
    buffer_load_dword v57, v44, s[36:39], s93 offen sc1
    s_mov_b32 s93, 797696
    buffer_load_dword v58, v44, s[36:39], s93 offen sc1
    s_mov_b32 s93, 798720
    buffer_load_dword v59, v44, s[36:39], s93 offen sc1
    s_mov_b32 s93, 799744
    buffer_load_dword v60, v44, s[36:39], s93 offen sc1
    s_mov_b32 s93, 800768
    buffer_load_dword v61, v44, s[36:39], s93 offen sc1
    s_waitcnt vmcnt(0)
    v_add_f32 v32, v48, v49
    v_add_f32 v33, v50, v51
    v_add_f32 v32, v32, v52
    v_add_f32 v33, v33, v53
    v_add_f32 v32, v32, v54
    v_add_f32 v33, v33, v55
    v_add_f32 v32, v32, v56
    v_add_f32 v33, v33, v57
    v_add_f32 v32, v32, v58
    v_add_f32 v33, v33, v59
    v_add_f32 v32, v32, v60
    v_add_f32 v33, v33, v61
    v_cmp_u_f32 vcc, v32, v33
    s_cbranch_vccz L_D_OK
    s_add_u32 s99, s99, 1
    s_cmp_lt_u32 s99, 262144
    s_cbranch_scc1 L_D_RETRY
L_D_OK:
    v_lshlrev_b32 v32, 16, v96
    v_and_b32 v33, 0xffff0000, v96
    v_lshlrev_b32 v34, 16, v97
    v_and_b32 v35, 0xffff0000, v97
    v_lshlrev_b32 v36, 16, v98
    v_and_b32 v37, 0xffff0000, v98
    v_lshlrev_b32 v38, 16, v99
    v_and_b32 v39, 0xffff0000, v99
    v_pk_mul_f32 v[16:17], v[32:33], v[48:49] op_sel_hi:[1,0]
    v_pk_mul_f32 v[18:19], v[34:35], v[48:49] op_sel_hi:[1,0]
    v_pk_mul_f32 v[20:21], v[36:37], v[48:49] op_sel_hi:[1,0]
    v_pk_mul_f32 v[22:23], v[38:39], v[48:49] op_sel_hi:[1,0]
    v_pk_mul_f32 v[24:25], v[32:33], v[54:55] op_sel:[0,1] op_sel_hi:[1,1]
    v_pk_mul_f32 v[26:27], v[34:35], v[54:55] op_sel:[0,1] op_sel_hi:[1,1]
    v_pk_mul_f32 v[28:29], v[36:37], v[54:55] op_sel:[0,1] op_sel_hi:[1,1]
    v_pk_mul_f32 v[30:31], v[38:39], v[54:55] op_sel:[0,1] op_sel_hi:[1,1]
    v_lshlrev_b32 v32, 16, v100
    v_and_b32 v33, 0xffff0000, v100
    v_lshlrev_b32 v34, 16, v101
    v_and_b32 v35, 0xffff0000, v101
    v_lshlrev_b32 v36, 16, v102
    v_and_b32 v37, 0xffff0000, v102
    v_lshlrev_b32 v38, 16, v103
    v_and_b32 v39, 0xffff0000, v103
    v_pk_fma_f32 v[16:17], v[32:33], v[48:49], v[16:17] op_sel:[0,1,0] op_sel_hi:[1,1,1]
    v_pk_fma_f32 v[18:19], v[34:35], v[48:49], v[18:19] op_sel:[0,1,0] op_sel_hi:[1,1,1]
    v_pk_fma_f32 v[20:21], v[36:37], v[48:49], v[20:21] op_sel:[0,1,0] op_sel_hi:[1,1,1]
    v_pk_fma_f32 v[22:23], v[38:39], v[48:49], v[22:23] op_sel:[0,1,0] op_sel_hi:[1,1,1]
    v_pk_fma_f32 v[24:25], v[32:33], v[56:57], v[24:25] op_sel_hi:[1,0,1]
    v_pk_fma_f32 v[26:27], v[34:35], v[56:57], v[26:27] op_sel_hi:[1,0,1]
    v_pk_fma_f32 v[28:29], v[36:37], v[56:57], v[28:29] op_sel_hi:[1,0,1]
    v_pk_fma_f32 v[30:31], v[38:39], v[56:57], v[30:31] op_sel_hi:[1,0,1]
    v_lshlrev_b32 v32, 16, v104
    v_and_b32 v33, 0xffff0000, v104
    v_lshlrev_b32 v34, 16, v105
    v_and_b32 v35, 0xffff0000, v105
    v_lshlrev_b32 v36, 16, v106
    v_and_b32 v37, 0xffff0000, v106
    v_lshlrev_b32 v38, 16, v107
    v_and_b32 v39, 0xffff0000, v107
    v_pk_fma_f32 v[16:17], v[32:33], v[50:51], v[16:17] op_sel_hi:[1,0,1]
    v_pk_fma_f32 v[18:19], v[34:35], v[50:51], v[18:19] op_sel_hi:[1,0,1]
    v_pk_fma_f32 v[20:21], v[36:37], v[50:51], v[20:21] op_sel_hi:[1,0,1]
    v_pk_fma_f32 v[22:23], v[38:39], v[50:51], v[22:23] op_sel_hi:[1,0,1]
    v_pk_fma_f32 v[24:25], v[32:33], v[56:57], v[24:25] op_sel:[0,1,0] op_sel_hi:[1,1,1]
    v_pk_fma_f32 v[26:27], v[34:35], v[56:57], v[26:27] op_sel:[0,1,0] op_sel_hi:[1,1,1]
    v_pk_fma_f32 v[28:29], v[36:37], v[56:57], v[28:29] op_sel:[0,1,0] op_sel_hi:[1,1,1]
    v_pk_fma_f32 v[30:31], v[38:39], v[56:57], v[30:31] op_sel:[0,1,0] op_sel_hi:[1,1,1]
    v_lshlrev_b32 v32, 16, v108
    v_and_b32 v33, 0xffff0000, v108
    v_lshlrev_b32 v34, 16, v109
    v_and_b32 v35, 0xffff0000, v109
    v_lshlrev_b32 v36, 16, v110
    v_and_b32 v37, 0xffff0000, v110
    v_lshlrev_b32 v38, 16, v111
    v_and_b32 v39, 0xffff0000, v111
    v_pk_fma_f32 v[16:17], v[32:33], v[50:51], v[16:17] op_sel:[0,1,0] op_sel_hi:[1,1,1]
    v_pk_fma_f32 v[18:19], v[34:35], v[50:51], v[18:19] op_sel:[0,1,0] op_sel_hi:[1,1,1]
    v_pk_fma_f32 v[20:21], v[36:37], v[50:51], v[20:21] op_sel:[0,1,0] op_sel_hi:[1,1,1]
    v_pk_fma_f32 v[22:23], v[38:39], v[50:51], v[22:23] op_sel:[0,1,0] op_sel_hi:[1,1,1]
    v_pk_fma_f32 v[24:25], v[32:33], v[58:59], v[24:25] op_sel_hi:[1,0,1]
    v_pk_fma_f32 v[26:27], v[34:35], v[58:59], v[26:27] op_sel_hi:[1,0,1]
    v_pk_fma_f32 v[28:29], v[36:37], v[58:59], v[28:29] op_sel_hi:[1,0,1]
    v_pk_fma_f32 v[30:31], v[38:39], v[58:59], v[30:31] op_sel_hi:[1,0,1]
    v_lshlrev_b32 v32, 16, v112
    v_and_b32 v33, 0xffff0000, v112
    v_lshlrev_b32 v34, 16, v113
    v_and_b32 v35, 0xffff0000, v113
    v_lshlrev_b32 v36, 16, v114
    v_and_b32 v37, 0xffff0000, v114
    v_lshlrev_b32 v38, 16, v115
    v_and_b32 v39, 0xffff0000, v115
    v_pk_fma_f32 v[16:17], v[32:33], v[52:53], v[16:17] op_sel_hi:[1,0,1]
    v_pk_fma_f32 v[18:19], v[34:35], v[52:53], v[18:19] op_sel_hi:[1,0,1]
    v_pk_fma_f32 v[20:21], v[36:37], v[52:53], v[20:21] op_sel_hi:[1,0,1]
    v_pk_fma_f32 v[22:23], v[38:39], v[52:53], v[22:23] op_sel_hi:[1,0,1]
    v_pk_fma_f32 v[24:25], v[32:33], v[58:59], v[24:25] op_sel:[0,1,0] op_sel_hi:[1,1,1]
    v_pk_fma_f32 v[26:27], v[34:35], v[58:59], v[26:27] op_sel:[0,1,0] op_sel_hi:[1,1,1]
    v_pk_fma_f32 v[28:29], v[36:37], v[58:59], v[28:29] op_sel:[0,1,0] op_sel_hi:[1,1,1]
    v_pk_fma_f32 v[30:31], v[38:39], v[58:59], v[30:31] op_sel:[0,1,0] op_sel_hi:[1,1,1]
    v_lshlrev_b32 v32, 16, v116
    v_and_b32 v33, 0xffff0000, v116
    v_lshlrev_b32 v34, 16, v117
    v_and_b32 v35, 0xffff0000, v117
    v_lshlrev_b32 v36, 16, v118
    v_and_b32 v37, 0xffff0000, v118
    v_lshlrev_b32 v38, 16, v119
    v_and_b32 v39, 0xffff0000, v119
    v_pk_fma_f32 v[16:17], v[32:33], v[52:53], v[16:17] op_sel:[0,1,0] op_sel_hi:[1,1,1]
    v_pk_fma_f32 v[18:19], v[34:35], v[52:53], v[18:19] op_sel:[0,1,0] op_sel_hi:[1,1,1]
    v_pk_fma_f32 v[20:21], v[36:37], v[52:53], v[20:21] op_sel:[0,1,0] op_sel_hi:[1,1,1]
    v_pk_fma_f32 v[22:23], v[38:39], v[52:53], v[22:23] op_sel:[0,1,0] op_sel_hi:[1,1,1]
    v_pk_fma_f32 v[24:25], v[32:33], v[60:61], v[24:25] op_sel_hi:[1,0,1]
    v_pk_fma_f32 v[26:27], v[34:35], v[60:61], v[26:27] op_sel_hi:[1,0,1]
    v_pk_fma_f32 v[28:29], v[36:37], v[60:61], v[28:29] op_sel_hi:[1,0,1]
    v_pk_fma_f32 v[30:31], v[38:39], v[60:61], v[30:31] op_sel_hi:[1,0,1]
    v_lshlrev_b32 v32, 16, v120
    v_and_b32 v33, 0xffff0000, v120
    v_lshlrev_b32 v34, 16, v121
    v_and_b32 v35, 0xffff0000, v121
    v_lshlrev_b32 v36, 16, v122
    v_and_b32 v37, 0xffff0000, v122
    v_lshlrev_b32 v38, 16, v123
    v_and_b32 v39, 0xffff0000, v123
    v_pk_fma_f32 v[16:17], v[32:33], v[54:55], v[16:17] op_sel_hi:[1,0,1]
    v_pk_fma_f32 v[18:19], v[34:35], v[54:55], v[18:19] op_sel_hi:[1,0,1]
    v_pk_fma_f32 v[20:21], v[36:37], v[54:55], v[20:21] op_sel_hi:[1,0,1]
    v_pk_fma_f32 v[22:23], v[38:39], v[54:55], v[22:23] op_sel_hi:[1,0,1]
    v_pk_fma_f32 v[24:25], v[32:33], v[60:61], v[24:25] op_sel:[0,1,0] op_sel_hi:[1,1,1]
    v_pk_fma_f32 v[26:27], v[34:35], v[60:61], v[26:27] op_sel:[0,1,0] op_sel_hi:[1,1,1]
    v_pk_fma_f32 v[28:29], v[36:37], v[60:61], v[28:29] op_sel:[0,1,0] op_sel_hi:[1,1,1]
    v_pk_fma_f32 v[30:31], v[38:39], v[60:61], v[30:31] op_sel:[0,1,0] op_sel_hi:[1,1,1]
    s_nop 1
    v_permlane32_swap_b32 v16, v24
    v_permlane32_swap_b32 v17, v25
    v_permlane32_swap_b32 v18, v26
    v_permlane32_swap_b32 v19, v27
    v_permlane32_swap_b32 v20, v28
    v_permlane32_swap_b32 v21, v29
    v_permlane32_swap_b32 v22, v30
    v_permlane32_swap_b32 v23, v31
    s_nop 1
    v_add_f32 v16, v16, v24
    v_add_f32 v17, v17, v25
    v_add_f32 v18, v18, v26
    v_add_f32 v19, v19, v27
    v_add_f32 v20, v20, v28
    v_add_f32 v21, v21, v29
    v_add_f32 v22, v22, v30
    v_add_f32 v23, v23, v31
    s_nop 1
    v_permlane16_swap_b32 v16, v20
    v_permlane16_swap_b32 v17, v21
    v_permlane16_swap_b32 v18, v22
    v_permlane16_swap_b32 v19, v23
    s_nop 1
    v_add_f32 v16, v16, v20
    v_add_f32 v17, v17, v21
    v_add_f32 v18, v18, v22
    v_add_f32 v19, v19, v23
    s_nop 1
    v_add_f32_dpp v16, v16, v16 row_ror:8 row_mask:0xf bank_mask:0xf
    v_add_f32_dpp v17, v17, v17 row_ror:8 row_mask:0xf bank_mask:0xf
    v_add_f32_dpp v18, v18, v18 row_ror:8 row_mask:0xf bank_mask:0xf
    v_add_f32_dpp v19, v19, v19 row_ror:8 row_mask:0xf bank_mask:0xf
    v_add_f32_dpp v16, v16, v16 row_ror:4 row_mask:0xf bank_mask:0xf
    v_add_f32_dpp v17, v17, v17 row_ror:4 row_mask:0xf bank_mask:0xf
    v_add_f32_dpp v18, v18, v18 row_ror:4 row_mask:0xf bank_mask:0xf
    v_add_f32_dpp v19, v19, v19 row_ror:4 row_mask:0xf bank_mask:0xf
    v_add_f32_dpp v16, v16, v16 row_ror:2 row_mask:0xf bank_mask:0xf
    v_add_f32_dpp v17, v17, v17 row_ror:2 row_mask:0xf bank_mask:0xf
    v_add_f32_dpp v18, v18, v18 row_ror:2 row_mask:0xf bank_mask:0xf
    v_add_f32_dpp v19, v19, v19 row_ror:2 row_mask:0xf bank_mask:0xf
    v_add_f32_dpp v16, v16, v16 row_ror:1 row_mask:0xf bank_mask:0xf
    v_add_f32_dpp v17, v17, v17 row_ror:1 row_mask:0xf bank_mask:0xf
    v_add_f32_dpp v18, v18, v18 row_ror:1 row_mask:0xf bank_mask:0xf
    v_add_f32_dpp v19, v19, v19 row_ror:1 row_mask:0xf bank_mask:0xf
    s_nop 1
    v_lshlrev_b32 v44, 6, v2
    v_and_b32 v40, 48, v0
    v_add_u32 v44, v44, v40
    ds_write_b128 v44, v[16:19] offset:64448
    s_waitcnt lgkmcnt(0)
    s_barrier
    s_cmp_lg_u32 s14, 0
    s_cbranch_scc1 L_DONE
    s_mov_b64 exec, 0xffff
    v_lshlrev_b32 v44, 2, v0
    ds_read_b32 v16, v44 offset:64448
    ds_read_b32 v17, v44 offset:64512
    ds_read_b32 v18, v44 offset:64576
    ds_read_b32 v19, v44 offset:64640
    v_lshrrev_b32 v41, 3, v0
    v_and_b32 v40, 7, v0
    v_lshlrev_b32 v41, 9, v41
    v_add_u32 v41, v41, v40
    s_lshl_b32 s93, s13, 3
    v_add_u32 v41, s93, v41
    v_lshlrev_b32 v3, 2, v41
    ds_read_b32 v32, v3 offset:58176
    s_waitcnt lgkmcnt(0)
    v_add_f32 v16, v16, v17
    v_add_f32 v16, v16, v18
    v_add_f32 v16, v16, v19
    v_cvt_pk_bf16_f32 v33, v16, v16
    v_lshlrev_b32 v16, 16, v33
    v_add_f32 v16, v16, v32
    v_cvt_pk_bf16_f32 v16, v16, v16
    v_lshlrev_b32 v3, 1, v41
    buffer_store_short v16, v3, s[60:63], 0 offen
    s_mov_b64 exec, -1
L_DONE:
    s_endpgm
.section .rodata,"a"
.p2align 6
.amdhsa_kernel sequential_preLN__mha_block_cached__swiglu_ffn__decode_kernel
  .amdhsa_next_free_vgpr 128
  .amdhsa_next_free_sgpr 102
  .amdhsa_accum_offset 128
  .amdhsa_group_segment_fixed_size 0
  .amdhsa_kernarg_size 96
  .amdhsa_user_sgpr_count 2
  .amdhsa_user_sgpr_kernarg_segment_ptr 1
  .amdhsa_system_sgpr_workgroup_id_x 1
  .amdhsa_float_denorm_mode_32 3
.end_amdhsa_kernel
```
